```python
import torch

def _softmax(x, axis=-1):
    return torch.softmax(x, dim=axis)
def _gelu(x):
    return torch.nn.functional.gelu(x, approximate="tanh")
def _silu(x):
    return torch.nn.functional.silu(x)
def _sigmoid(x):
    return torch.sigmoid(x)
def _layernorm(x, axis=-1, eps=1e-5):
    m = x.mean(dim=axis, keepdim=True)
    v = x.var(dim=axis, keepdim=True, unbiased=False)
    return (x - m) / torch.sqrt(v + eps)
def _scatter_add(tgt, idx, src, axis=0):
    return tgt.clone().index_add_(axis, idx, src)
def _segment_sum(src, seg, n):
    out = torch.zeros((n,) + src.shape[1:], dtype=src.dtype)
    return out.index_add_(0, seg, src)
def _pad(x, pw):
    flat = tuple(v for pair in reversed(pw) for v in pair)
    return torch.nn.functional.pad(x, flat)

kernel_name = 'gated_mix__mha_block__glu_gated_glu__prompt'

def setup_inputs():

    _w = (lambda a: (lambda t: t.to(torch.bfloat16) if t.is_floating_point() else t)(torch.as_tensor(a)))
    def _A_setup():
        B, S, D, H = 1, 2048, 512, 32
        return {
            "x": _w((lambda *s: torch.randn(*s, dtype=torch.bfloat16) * 0.05)(B, S, D)),
            "wqkv": _w((lambda *s: torch.randn(*s, dtype=torch.bfloat16) * 0.8)(D, 3 * D)),
            "wo": _w((lambda *s: torch.randn(*s, dtype=torch.bfloat16) * 0.1)(D, D)),
        }
    _A_in = _A_setup()

    def _B_setup():
        B, S, D, F = 1, 2048, 512, 1792
        return {
            "x": _w((lambda *s: torch.randn(*s, dtype=torch.bfloat16) * 0.05)(B, S, D)),
            "w_gate": _w((lambda *s: torch.randn(*s, dtype=torch.bfloat16) * 0.4)(D, F)),
            "w_up": _w((lambda *s: torch.randn(*s, dtype=torch.bfloat16) * 0.05)(D, F)),
            "w_down": _w((lambda *s: torch.randn(*s, dtype=torch.bfloat16) * 0.05)(F, D)),
        }
    _B_in = _B_setup()

    return {
        "A_x": _A_in["x"],
        "A_wqkv": _A_in["wqkv"],
        "A_wo": _A_in["wo"],
        "B_x": _B_in["x"],
        "B_w_gate": _B_in["w_gate"],
        "B_w_up": _B_in["w_up"],
        "B_w_down": _B_in["w_down"],
        "gate_w": _w((lambda *s: torch.randn(*s, dtype=torch.bfloat16) * 0.05)(512) * 16.0),
    }

def reference(A_x, A_wqkv, A_wo, B_x, B_w_gate, B_w_up, B_w_down, gate_w):
    def _A_ref(x, wqkv, wo):
        B, S, D = x.shape
        H = 32
        Dh = D // H
        qkv = (lambda x, *d: x.permute(*d))((x @ wqkv).reshape(B, S, 3, H, Dh), 2, 0, 3, 1, 4)
        q, k, v = qkv[0], qkv[1], qkv[2]
        scores = torch.einsum("bhqd,bhkd->bhqk", q, k) * (Dh ** -0.5)
        p = _softmax(scores, axis=-1)
        o = torch.einsum("bhqk,bhkd->bhqd", p, v)
        return (lambda x, *d: x.permute(*d))(o, 0, 2, 1, 3).reshape(B, S, D) @ wo

    def _B_ref(x, w_gate, w_up, w_down):
        g = torch.einsum("bsd,df->bsf", x, w_gate)
        u = torch.einsum("bsd,df->bsf", x, w_up)
        h = _sigmoid(g) * u
        return torch.einsum("bsf,fd->bsd", h, w_down)

    x = A_x
    g = _sigmoid((x * gate_w).sum(-1, keepdims=True))
    a = _A_ref(x, A_wqkv, A_wo)
    b = _B_ref(x, B_w_gate, B_w_up, B_w_down)
    return g * a + (1 - g) * b
```

```asm
; @launch grid=(256,1,1) block=(512,1,1) lds=163840
.amdgcn_target "amdgcn-amd-amdhsa--gfx950"
.text
.globl gated_mix__mha_block__glu_gated_glu__prompt_kernel
.p2align 8
.type gated_mix__mha_block__glu_gated_glu__prompt_kernel,@function
gated_mix__mha_block__glu_gated_glu__prompt_kernel:
    s_load_dwordx2 s[4:5], s[0:1], 0
    s_load_dwordx2 s[8:9], s[0:1], 8
    s_load_dwordx2 s[16:17], s[0:1], 32
    s_load_dwordx2 s[20:21], s[0:1], 40
    s_load_dwordx2 s[28:29], s[0:1], 56
    s_cmp_ge_u32 s2, 256
    s_cbranch_scc1 L_end
    s_getpc_b64 s[98:99]
    s_bfe_u32 s3, s2, 0x20003
    s_lshl_b32 s3, s3, 13
    v_and_b32 v1, 0x1f8, v0
    v_lshl_add_u32 v1, v1, 4, s3
    v_mov_b32 v3, s99
    v_add_co_u32 v2, vcc, s98, v1
    v_lshrrev_b32 v10, 6, v0
    v_and_b32 v0, 63, v0
    v_addc_co_u32 v3, vcc, 0, v3, vcc
    global_load_dword v124, v[2:3], off
    v_readfirstlane_b32 s52, v10
    s_and_b32 s81, s2, 7
    s_lshr_b32 s82, s2, 3
    s_and_b32 s54, s2, 1
    s_lshr_b32 s56, s2, 6
    s_lshl2_add_u32 s54, s54, s56
    s_and_b32 s57, s82, 7
    s_lshr_b32 s53, s81, 1
    s_lshl3_add_u32 s53, s53, s57
    s_lshr_b32 s55, s81, 1
    s_and_b32 s3, s81, 1
    s_lshl1_add_u32 s55, s3, s55
    s_add_u32 s3, s53, s54
    s_lshl2_add_u32 s55, s3, s55
    s_and_b32 s55, s55, 7
    s_lshl2_add_u32 s56, s81, s56
    v_lshlrev_b32 v1, 4, v0
    v_lshrrev_b32 v78, 4, v0
    v_and_b32 v79, 7, v0
    v_xor_b32 v78, v78, v79
    v_lshlrev_b32 v78, 4, v78
    v_lshrrev_b32 v79, 3, v0
    v_lshl_add_u32 v64, v79, 10, v78
    v_xor_b32 v65, 64, v64
    v_add_u32 v65, 7168, v65
    v_add_u32 v66, 14336, v64
    v_add_u32 v67, 14336, v65
    s_mul_i32 s58, s52, 12288
    s_add_u32 s58, s58, 65536
    s_lshl3_add_u32 s59, s54, s52
    s_lshl_b32 s61, s59, 15
    s_mov_b32 s6, 2097152
    s_mov_b32 s7, 0x20000
    s_lshl_b32 s3, s55, 7
    s_mov_b32 m0, s58
    s_add_u32 s83, s3, s61
    s_waitcnt lgkmcnt(0)
    buffer_load_dwordx4 v64, s[4:7], s83 offen lds
    buffer_load_dwordx4 v65, s[4:7], s83 offen offset:1024 lds
    buffer_load_dwordx4 v66, s[4:7], s83 offen offset:2048 lds
    buffer_load_dwordx4 v67, s[4:7], s83 offen offset:3072 lds
    s_lshl_b32 s62, s52, 11
    s_and_b32 s60, s53, 3
    s_lshr_b32 s3, s53, 3
    s_mul_i32 s76, s3, 7
    s_bfe_u32 s65, s53, 0x10002
    s_add_u32 s64, s65, s76
    s_add_u32 s64, s64, 3
    s_lshr_b32 s3, s53, 2
    s_lshl3_add_u32 s3, s60, s3
    s_cmp_lt_u32 s60, 3
    s_cselect_b32 s64, s3, s64
    s_cselect_b64 s[44:45], s[16:17], s[20:21]
    s_cselect_b64 s[8:9], s[8:9], s[16:17]
    s_cselect_b32 s66, 6, 7
    s_lshl_b32 s10, s66, 18
    s_mov_b32 s11, s7
    s_lshl_b32 s64, s64, 7
    s_lshl_b32 s3, s66, 9
    s_lshl_b32 s66, s66, 13
    v_mul_u32_u24 v75, s3, v79
    v_lshrrev_b32 v78, 2, v1
    v_and_b32 v78, 64, v78
    v_xor_b32 v78, v78, v1
    v_and_b32 v78, 0x70, v78
    v_add_u32 v75, v75, v78
    s_lshl_b32 s3, s3, 3
    s_sub_u32 s3, s3, 1024
    v_add_u32 v76, s3, v75
    s_lshl2_add_u32 s63, s55, s52
    s_and_b32 s63, s63, 31
    s_mul_i32 s3, s63, s66
    s_mov_b32 m0, s62
    s_add_u32 s67, s3, s64
    buffer_load_dwordx4 v75, s[8:11], s67 offen lds
    buffer_load_dwordx4 v76, s[8:11], s67 offen offset:1024 lds
    s_movk_i32 s30, 1024
    s_mov_b32 s31, s7
    s_add_u32 m0, s62, 49152
    s_lshr_b32 s50, s57, 1
    s_add_u32 s3, s55, s50
    s_and_b32 s3, s3, 7
    s_lshl_b32 s3, s3, 7
    s_mov_b64 exec, 0xff
    buffer_load_dwordx4 v1, s[28:31], s3 offen lds
    s_mov_b64 exec, -1
    s_load_dwordx2 s[40:41], s[0:1], 80
    s_load_dwordx2 s[36:37], s[0:1], 72
    s_load_dwordx2 s[12:13], s[0:1], 16
    s_load_dwordx2 s[24:25], s[0:1], 48
    s_load_dwordx2 s[32:33], s[0:1], 64
    s_mov_b32 s18, 1835008
    s_mov_b32 s19, s7
    s_mov_b32 s22, s18
    s_mov_b32 s23, s7
    s_add_u32 s3, s55, 1
    s_and_b32 s3, s3, 7
    s_lshl_b32 s3, s3, 7
    s_add_u32 m0, s58, 4096
    s_add_u32 s83, s3, s61
    buffer_load_dwordx4 v64, s[4:7], s83 offen lds
    v_and_b32 v78, 31, v0
    v_lshl_add_u32 v9, v78, 7, s58
    v_bfe_u32 v78, v0, 1, 3
    v_lshrrev_b32 v79, 5, v0
    v_xor_b32 v78, v78, v79
    v_lshl_add_u32 v68, v78, 4, v9
    v_xor_b32 v69, 32, v68
    v_xor_b32 v70, 64, v68
    v_xor_b32 v71, 96, v68
    buffer_load_dwordx4 v65, s[4:7], s83 offen offset:1024 lds
    v_bfe_u32 v78, v0, 2, 2
    v_lshl_add_u32 v78, v79, 3, v78
    v_and_b32 v9, 3, v0
    v_lshlrev_b32 v9, 3, v9
    v_and_b32 v8, 16, v0
    v_lshl_add_u32 v4, v8, 1, v9
    v_lshl_add_u32 v72, v78, 7, v4
    v_and_b32 v77, 8, v0
    v_lshl_add_u32 v72, v77, 3, v72
    v_xor_b32 v77, 64, v72
    s_add_u32 s3, s62, 49152
    v_lshl_add_u32 v74, v79, 4, s3
    buffer_load_dwordx4 v66, s[4:7], s83 offen offset:2048 lds
    s_lshr_b32 s3, s2, 2
    s_or_b32 s48, s3, s52
    s_waitcnt lgkmcnt(0)
    s_cbranch_scc0 L_lead
L_lead_b:
    s_mov_b32 s42, 33554432
    s_mov_b32 s43, s7
    s_movk_i32 s38, 256
    s_mov_b32 s39, s7
    s_mov_b32 s46, s18
    s_mov_b32 s47, s7
    v_lshl_add_u32 v14, v78, 5, v9
    v_lshl_add_u32 v14, v8, 7, v14
    v_add_u32 v14, 65536, v14
    v_add_u32 v15, 49152, v14
    v_lshl_add_u32 v4, v78, 6, v4
    v_add_u32 v4, 65536, v4
    v_add_u32 v5, 49152, v4
    v_and_b32 v2, 0x2f0, v1
    v_add_u32 v2, 1024, v2
    v_mov_b32 v24, 0
    v_mov_b32 v25, 0
    v_mov_b32 v26, 0
    v_mov_b32 v27, 0
    v_mov_b32 v28, 0
    v_mov_b32 v29, 0
    v_mov_b32 v30, 0
    v_mov_b32 v31, 0
    s_lshl2_add_u32 s3, s52, 49664
    v_mov_b32 v8, s3
    v_and_b32 v78, 7, v0
    v_lshlrev_b32 v9, 2, v78
    v_add_u32 v9, 49664, v9
    v_lshlrev_b32 v13, 15, v78
    s_mov_b32 exec_lo, 0x10000
    s_mov_b32 exec_hi, 0x10000
    v_mov_b32 v24, 0x3f803f80
    v_mov_b32 v25, v24
    v_mov_b32 v26, v24
    v_mov_b32 v27, v24
    v_mov_b32 v28, v24
    v_mov_b32 v29, v24
    v_mov_b32 v30, v24
    v_mov_b32 v31, v24
    s_mov_b64 exec, -1
    v_and_b32 v3, 0x1ff, v72
    v_lshl_add_u32 v3, v79, 9, v3
    v_add_u32 v3, s58, v3
    v_lshrrev_b32 v78, 1, v0
    v_mul_u32_u24 v125, 3584, v78
    v_and_b32 v78, 16, v1
    v_add_u32 v125, v78, v125
    v_lshrrev_b32 v78, 2, v0
    v_mul_u32_u24 v12, 3584, v78
    v_and_b32 v78, 48, v1
    v_add_u32 v12, v78, v12
    s_add_u32 s81, s55, s52
    s_and_b32 s81, s81, 7
    s_mul_i32 s81, s81, 229376
    s_lshl_b32 s76, s76, 7
    s_lshl_b32 s3, s57, 5
    s_add_u32 s77, s76, s3
    s_add_u32 s77, s77, s81
    s_add_u32 s77, s77, 640
    s_sub_u32 s3, s57, s65
    s_lshl1_add_u32 s65, s65, 6
    s_add_u32 s1, s65, 1
    s_cmp_lt_u32 s60, 3
    s_cselect_b32 s1, s3, s1
    s_cselect_b32 s3, s3, s65
    s_lshl_b32 s65, s1, 6
    s_add_u32 s65, s65, s76
    s_lshl_b32 s3, s3, 6
    s_add_u32 s76, s76, s3
    s_lshl_b32 s3, s53, 7
    s_lshl_b32 s71, s59, 12
    s_add_u32 s71, s71, s3
    s_add_u32 s68, s71, 22020096
    s_and_b32 s71, s71, 0x3fc00
    s_and_b32 s72, s71, 0x7c00
    s_lshr_b32 s3, s59, 1
    s_mul_i32 s73, s3, 294912
    s_and_b32 s3, s52, 1
    s_lshl_b32 s3, s3, 10
    s_add_u32 s73, s73, s3
    s_add_u32 s73, s73, 5242880
    s_lshr_b32 s3, s53, 3
    s_mul_i32 s3, s3, 57344
    s_add_u32 s78, s3, s73
    s_lshl_b32 s3, s53, 11
    s_add_u32 s3, s3, s73
    s_add_u32 s73, s3, 229376
    s_lshl_b32 s81, s53, 17
    s_lshl_b32 s3, s59, 11
    s_add_u32 s79, s81, s3
    s_and_b32 s69, s79, 0x39ffff
    s_add_u32 s79, s79, 17825792
    s_add_u32 s70, s62, s81
    s_add_u32 s70, s70, 1048576
    s_cmp_eq_u32 s60, 0
    s_cselect_b32 s3, 16777216, 0
    s_add_u32 s69, s69, s3
    s_add_u32 s69, s69, 1048576
    s_lshr_b32 s3, s52, 1
    s_mul_i32 s3, s3, 28
    s_and_b32 s81, s52, 1
    s_add_u32 s3, s3, s81
    s_lshl_b32 s75, s3, 14
    s_lshl_b32 s81, s57, 7
    s_add_u32 s75, s75, s81
    s_mul_i32 s74, s56, 294912
    s_mul_i32 s3, s52, 28672
    s_add_u32 s74, s74, s3
    s_add_u32 s74, s74, 5242880
    s_mov_b32 s14, 524288
    s_mov_b32 s15, s7
    s_mov_b32 s26, s18
    s_mov_b32 s27, s7
    s_mov_b32 s34, s6
    s_mov_b32 s35, s7
    buffer_load_dwordx4 v67, s[4:7], s83 offen offset:3072 lds
    v_lshlrev_b32 v6, 3, v1
    s_and_b32 s3, s2, 1
    s_lshl_b32 s3, s3, 8
    s_add_u32 s3, s3, s52
    s_and_b32 s0, s2, 0xf8
    s_add_u32 s3, s3, s0
    s_lshr_b32 s0, s53, 3
    s_lshl2_add_u32 s3, s3, s0
    s_mul_i32 s3, s3, 896
    s_add_u32 m0, s62, 50176
    s_mov_b64 exec, 7
    buffer_load_dword v6, s[16:19], s3 offen lds
    s_mov_b64 exec, 31
    buffer_load_dword v6, s[20:23], s3 offen lds
    s_mov_b64 exec, -1
    s_waitcnt vmcnt(9)
    ds_read_b128 v[128:131], v68 offset:0
    ds_read_b128 v[132:135], v69 offset:0
    ds_read_b128 v[136:139], v70 offset:0
    ds_read_b128 v[140:143], v71 offset:0
    s_waitcnt vmcnt(7)
    s_barrier
    ds_read_b64_tr_b16 v[48:49], v72 offset:0
    ds_read_b64_tr_b16 v[50:51], v72 offset:512
    ds_read_b64_tr_b16 v[52:53], v77 offset:0
    ds_read_b64_tr_b16 v[54:55], v77 offset:512
    ds_read_b64_tr_b16 v[56:57], v72 offset:2048
    ds_read_b64_tr_b16 v[58:59], v72 offset:2560
    ds_read_b64_tr_b16 v[60:61], v77 offset:2048
    ds_read_b64_tr_b16 v[62:63], v77 offset:2560
    s_cmp_eq_u32 s60, 2
    s_cbranch_scc1 L_r2
    s_setprio 2
    s_waitcnt lgkmcnt(6)
    v_mfma_f32_32x32x16_bf16 v[32:47], v[48:51], v[128:131], 0
    ds_read_b64_tr_b16 v[48:49], v72 offset:4096
    ds_read_b64_tr_b16 v[50:51], v72 offset:4608
    s_add_u32 s63, s63, 8
    s_and_b32 s63, s63, 31
    s_mul_i32 s3, s63, s66
    s_add_u32 m0, s62, 16384
    s_add_u32 s67, s3, s64
    buffer_load_dwordx4 v75, s[8:11], s67 offen lds
    buffer_load_dwordx4 v76, s[8:11], s67 offen offset:1024 lds
    s_waitcnt lgkmcnt(4)
    v_mfma_f32_32x32x16_bf16 v[32:47], v[56:59], v[132:135], v[32:47]
    ds_read_b64_tr_b16 v[56:57], v72 offset:6144
    ds_read_b64_tr_b16 v[58:59], v72 offset:6656
    s_add_u32 s3, s55, 2
    s_and_b32 s3, s3, 7
    s_lshl_b32 s3, s3, 7
    s_add_u32 m0, s58, 8192
    s_add_u32 s83, s3, s61
    buffer_load_dwordx4 v64, s[4:7], s83 offen lds
    buffer_load_dwordx4 v65, s[4:7], s83 offen offset:1024 lds
    s_setprio 1
    s_waitcnt lgkmcnt(2)
    v_mfma_f32_32x32x16_bf16 v[32:47], v[48:51], v[136:139], v[32:47]
    ds_read_b64_tr_b16 v[48:49], v72 offset:8192
    ds_read_b64_tr_b16 v[50:51], v72 offset:8704
    s_waitcnt vmcnt(10)
    ds_read_b128 v[80:83], v74 offset:0
    ds_read_b128 v[84:87], v74 offset:32
    ds_read_b128 v[88:91], v74 offset:64
    ds_read_b128 v[92:95], v74 offset:96
    buffer_load_dwordx4 v66, s[4:7], s83 offen offset:2048 lds
    s_waitcnt lgkmcnt(6)
    v_mfma_f32_32x32x16_bf16 v[32:47], v[56:59], v[140:143], v[32:47]
    s_waitcnt vmcnt(7)
    ds_read_b128 v[144:147], v68 offset:4096
    ds_read_b128 v[148:151], v69 offset:4096
    ds_read_b128 v[152:155], v70 offset:4096
    ds_read_b128 v[156:159], v71 offset:4096
    ds_read_b64_tr_b16 v[56:57], v72 offset:10240
    ds_read_b64_tr_b16 v[58:59], v72 offset:10752
    buffer_load_dwordx4 v67, s[4:7], s83 offen offset:3072 lds
    s_waitcnt lgkmcnt(6)
    s_cmp_eq_u32 s50, 0
    s_cbranch_scc0 L_dot_1
    v_dot2_f32_bf16 v112, v128, v80, 0
    v_dot2_f32_bf16 v113, v129, v81, 0
    v_dot2_f32_bf16 v114, v130, v82, 0
    v_dot2_f32_bf16 v115, v131, v83, 0
    v_dot2_f32_bf16 v112, v132, v84, v112
    v_dot2_f32_bf16 v113, v133, v85, v113
    v_dot2_f32_bf16 v114, v134, v86, v114
    v_dot2_f32_bf16 v115, v135, v87, v115
    v_dot2_f32_bf16 v112, v136, v88, v112
    v_dot2_f32_bf16 v113, v137, v89, v113
    v_dot2_f32_bf16 v114, v138, v90, v114
    v_dot2_f32_bf16 v115, v139, v91, v115
    v_dot2_f32_bf16 v112, v140, v92, v112
    v_dot2_f32_bf16 v113, v141, v93, v113
    v_dot2_f32_bf16 v114, v142, v94, v114
    v_dot2_f32_bf16 v115, v143, v95, v115
L_dot_1:
    s_setprio 0
    s_waitcnt lgkmcnt(5)
    v_mfma_f32_32x32x16_bf16 v[32:47], v[48:51], v[144:147], v[32:47]
    ds_read_b64_tr_b16 v[48:49], v72 offset:12288
    ds_read_b64_tr_b16 v[50:51], v72 offset:12800
    s_cmp_eq_u32 s48, 0
    s_cbranch_scc1 L_ldst_2
L_ldst_2_b:
    s_add_u32 s3, s55, 3
    s_and_b32 s3, s3, 7
    s_lshl_b32 s3, s3, 7
    s_mov_b32 m0, s58
    s_add_u32 s83, s3, s61
    buffer_load_dwordx4 v64, s[4:7], s83 offen lds
    s_waitcnt lgkmcnt(2)
    v_mfma_f32_32x32x16_bf16 v[32:47], v[56:59], v[148:151], v[32:47]
    ds_read_b64_tr_b16 v[56:57], v72 offset:14336
    ds_read_b64_tr_b16 v[58:59], v72 offset:14848
    buffer_load_dwordx4 v65, s[4:7], s83 offen offset:1024 lds
    s_setprio 3
    s_waitcnt lgkmcnt(2)
    v_mfma_f32_32x32x16_bf16 v[32:47], v[48:51], v[152:155], v[32:47]
    s_waitcnt vmcnt(6)
    s_barrier
    ds_read_b64_tr_b16 v[48:49], v72 offset:16384
    ds_read_b64_tr_b16 v[50:51], v72 offset:16896
    buffer_load_dwordx4 v66, s[4:7], s83 offen offset:2048 lds
    buffer_load_dwordx4 v67, s[4:7], s83 offen offset:3072 lds
    s_waitcnt lgkmcnt(2)
    v_mfma_f32_32x32x16_bf16 v[32:47], v[56:59], v[156:159], v[32:47]
    s_waitcnt vmcnt(4)
    ds_read_b128 v[160:163], v68 offset:8192
    ds_read_b128 v[164:167], v69 offset:8192
    ds_read_b128 v[168:171], v70 offset:8192
    ds_read_b128 v[172:175], v71 offset:8192
    ds_read_b64_tr_b16 v[56:57], v72 offset:18432
    ds_read_b64_tr_b16 v[58:59], v72 offset:18944
    s_cmp_eq_u32 s50, 1
    s_cbranch_scc0 L_dot_3
    v_dot2_f32_bf16 v112, v144, v80, 0
    v_dot2_f32_bf16 v113, v145, v81, 0
    v_dot2_f32_bf16 v114, v146, v82, 0
    v_dot2_f32_bf16 v115, v147, v83, 0
    v_dot2_f32_bf16 v112, v148, v84, v112
    v_dot2_f32_bf16 v113, v149, v85, v113
    v_dot2_f32_bf16 v114, v150, v86, v114
    v_dot2_f32_bf16 v115, v151, v87, v115
    v_dot2_f32_bf16 v112, v152, v88, v112
    v_dot2_f32_bf16 v113, v153, v89, v113
    v_dot2_f32_bf16 v114, v154, v90, v114
    v_dot2_f32_bf16 v115, v155, v91, v115
    v_dot2_f32_bf16 v112, v156, v92, v112
    v_dot2_f32_bf16 v113, v157, v93, v113
    v_dot2_f32_bf16 v114, v158, v94, v114
    v_dot2_f32_bf16 v115, v159, v95, v115
L_dot_3:
    s_add_u32 s63, s63, 8
    s_and_b32 s63, s63, 31
    s_mul_i32 s3, s63, s66
    s_add_u32 m0, s62, 32768
    s_add_u32 s67, s3, s64
    buffer_load_dwordx4 v75, s[8:11], s67 offen lds
    s_setprio 2
    s_waitcnt lgkmcnt(5)
    v_mfma_f32_32x32x16_bf16 v[32:47], v[48:51], v[160:163], v[32:47]
    ds_read_b64_tr_b16 v[48:49], v72 offset:20480
    ds_read_b64_tr_b16 v[50:51], v72 offset:20992
    buffer_load_dwordx4 v76, s[8:11], s67 offen offset:1024 lds
    s_waitcnt lgkmcnt(2)
    v_mfma_f32_32x32x16_bf16 v[32:47], v[56:59], v[164:167], v[32:47]
    ds_read_b64_tr_b16 v[56:57], v72 offset:22528
    ds_read_b64_tr_b16 v[58:59], v72 offset:23040
    s_add_u32 s3, s55, 4
    s_and_b32 s3, s3, 7
    s_lshl_b32 s3, s3, 7
    s_add_u32 m0, s58, 4096
    s_add_u32 s83, s3, s61
    buffer_load_dwordx4 v64, s[4:7], s83 offen lds
    buffer_load_dwordx4 v65, s[4:7], s83 offen offset:1024 lds
    s_setprio 1
    s_waitcnt lgkmcnt(2)
    v_mfma_f32_32x32x16_bf16 v[32:47], v[48:51], v[168:171], v[32:47]
    ds_read_b64_tr_b16 v[48:49], v72 offset:24576
    ds_read_b64_tr_b16 v[50:51], v72 offset:25088
    buffer_load_dwordx4 v66, s[4:7], s83 offen offset:2048 lds
    s_waitcnt lgkmcnt(2)
    v_mfma_f32_32x32x16_bf16 v[32:47], v[56:59], v[172:175], v[32:47]
    s_waitcnt vmcnt(5)
    ds_read_b128 v[176:179], v68 offset:0
    ds_read_b128 v[180:183], v69 offset:0
    ds_read_b128 v[184:187], v70 offset:0
    ds_read_b128 v[188:191], v71 offset:0
    ds_read_b64_tr_b16 v[56:57], v72 offset:26624
    ds_read_b64_tr_b16 v[58:59], v72 offset:27136
    buffer_load_dwordx4 v67, s[4:7], s83 offen offset:3072 lds
    s_cmp_eq_u32 s50, 2
    s_cbranch_scc0 L_dot_4
    v_dot2_f32_bf16 v112, v160, v80, 0
    v_dot2_f32_bf16 v113, v161, v81, 0
    v_dot2_f32_bf16 v114, v162, v82, 0
    v_dot2_f32_bf16 v115, v163, v83, 0
    v_dot2_f32_bf16 v112, v164, v84, v112
    v_dot2_f32_bf16 v113, v165, v85, v113
    v_dot2_f32_bf16 v114, v166, v86, v114
    v_dot2_f32_bf16 v115, v167, v87, v115
    v_dot2_f32_bf16 v112, v168, v88, v112
    v_dot2_f32_bf16 v113, v169, v89, v113
    v_dot2_f32_bf16 v114, v170, v90, v114
    v_dot2_f32_bf16 v115, v171, v91, v115
    v_dot2_f32_bf16 v112, v172, v92, v112
    v_dot2_f32_bf16 v113, v173, v93, v113
    v_dot2_f32_bf16 v114, v174, v94, v114
    v_dot2_f32_bf16 v115, v175, v95, v115
L_dot_4:
    s_setprio 0
    s_waitcnt lgkmcnt(5)
    v_mfma_f32_32x32x16_bf16 v[32:47], v[48:51], v[176:179], v[32:47]
    ds_read_b64_tr_b16 v[48:49], v72 offset:28672
    ds_read_b64_tr_b16 v[50:51], v72 offset:29184
    s_add_u32 s3, s55, 5
    s_and_b32 s3, s3, 7
    s_lshl_b32 s3, s3, 7
    s_add_u32 m0, s58, 8192
    s_add_u32 s83, s3, s61
    buffer_load_dwordx4 v64, s[4:7], s83 offen lds
    v_mfma_f32_32x32x16_bf16 v[96:111], v[52:55], v[128:131], 0
    ds_read_b64_tr_b16 v[52:53], v77 offset:4096
    ds_read_b64_tr_b16 v[54:55], v77 offset:4608
    buffer_load_dwordx4 v65, s[4:7], s83 offen offset:1024 lds
    s_waitcnt lgkmcnt(4)
    v_mfma_f32_32x32x16_bf16 v[32:47], v[56:59], v[180:183], v[32:47]
    ds_read_b64_tr_b16 v[56:57], v72 offset:30720
    ds_read_b64_tr_b16 v[58:59], v72 offset:31232
    v_mfma_f32_32x32x16_bf16 v[96:111], v[60:63], v[132:135], v[96:111]
    ds_read_b64_tr_b16 v[60:61], v77 offset:6144
    ds_read_b64_tr_b16 v[62:63], v77 offset:6656
    buffer_load_dwordx4 v66, s[4:7], s83 offen offset:2048 lds
    s_setprio 3
    s_waitcnt lgkmcnt(6)
    v_mfma_f32_32x32x16_bf16 v[32:47], v[48:51], v[184:187], v[32:47]
    s_waitcnt vmcnt(7)
    s_barrier
    ds_read_b64_tr_b16 v[48:49], v72 offset:32768
    ds_read_b64_tr_b16 v[50:51], v72 offset:33280
    s_waitcnt lgkmcnt(6)
    v_mfma_f32_32x32x16_bf16 v[96:111], v[52:55], v[136:139], v[96:111]
    ds_read_b64_tr_b16 v[52:53], v77 offset:8192
    ds_read_b64_tr_b16 v[54:55], v77 offset:8704
    buffer_load_dwordx4 v67, s[4:7], s83 offen offset:3072 lds
    s_waitcnt lgkmcnt(6)
    v_mfma_f32_32x32x16_bf16 v[32:47], v[56:59], v[188:191], v[32:47]
    s_waitcnt vmcnt(4)
    ds_read_b128 v[192:195], v68 offset:4096
    ds_read_b128 v[196:199], v69 offset:4096
    ds_read_b128 v[200:203], v70 offset:4096
    ds_read_b128 v[204:207], v71 offset:4096
    ds_read_b64_tr_b16 v[56:57], v72 offset:34816
    ds_read_b64_tr_b16 v[58:59], v72 offset:35328
    s_add_u32 s63, s63, 8
    s_and_b32 s63, s63, 31
    s_mul_i32 s3, s63, s66
    s_add_u32 m0, s62, 49152
    s_add_u32 s67, s3, s64
    buffer_load_dwordx4 v75, s[8:11], s67 offen lds
    s_cmp_eq_u32 s50, 3
    s_cbranch_scc0 L_dot_5
    v_dot2_f32_bf16 v112, v176, v80, 0
    v_dot2_f32_bf16 v113, v177, v81, 0
    v_dot2_f32_bf16 v114, v178, v82, 0
    v_dot2_f32_bf16 v115, v179, v83, 0
    v_dot2_f32_bf16 v112, v180, v84, v112
    v_dot2_f32_bf16 v113, v181, v85, v113
    v_dot2_f32_bf16 v114, v182, v86, v114
    v_dot2_f32_bf16 v115, v183, v87, v115
    v_dot2_f32_bf16 v112, v184, v88, v112
    v_dot2_f32_bf16 v113, v185, v89, v113
    v_dot2_f32_bf16 v114, v186, v90, v114
    v_dot2_f32_bf16 v115, v187, v91, v115
    v_dot2_f32_bf16 v112, v188, v92, v112
    v_dot2_f32_bf16 v113, v189, v93, v113
    v_dot2_f32_bf16 v114, v190, v94, v114
    v_dot2_f32_bf16 v115, v191, v95, v115
L_dot_5:
    s_waitcnt lgkmcnt(10)
    v_mfma_f32_32x32x16_bf16 v[96:111], v[60:63], v[140:143], v[96:111]
    ds_read_b64_tr_b16 v[60:61], v77 offset:10240
    ds_read_b64_tr_b16 v[62:63], v77 offset:10752
    s_setprio 2
    s_waitcnt lgkmcnt(7)
    v_mfma_f32_32x32x16_bf16 v[32:47], v[48:51], v[192:195], v[32:47]
    ds_read_b64_tr_b16 v[48:49], v72 offset:36864
    ds_read_b64_tr_b16 v[50:51], v72 offset:37376
    buffer_load_dwordx4 v76, s[8:11], s67 offen offset:1024 lds
    v_mfma_f32_32x32x16_bf16 v[96:111], v[52:55], v[144:147], v[96:111]
    ds_read_b64_tr_b16 v[52:53], v77 offset:12288
    ds_read_b64_tr_b16 v[54:55], v77 offset:12800
    s_waitcnt lgkmcnt(4)
    v_mfma_f32_32x32x16_bf16 v[96:111], v[60:63], v[148:151], v[96:111]
    ds_read_b64_tr_b16 v[60:61], v77 offset:14336
    ds_read_b64_tr_b16 v[62:63], v77 offset:14848
    s_add_u32 s3, s55, 6
    s_and_b32 s3, s3, 7
    s_lshl_b32 s3, s3, 7
    s_mov_b32 m0, s58
    s_add_u32 s83, s3, s61
    buffer_load_dwordx4 v64, s[4:7], s83 offen lds
    v_mfma_f32_32x32x16_bf16 v[32:47], v[56:59], v[196:199], v[32:47]
    ds_read_b64_tr_b16 v[56:57], v72 offset:38912
    ds_read_b64_tr_b16 v[58:59], v72 offset:39424
    v_add_f32 v112, v112, v113
    v_add_f32 v114, v114, v115
    v_add_f32 v126, v112, v114
    v_mov_b32 v127, v126
    s_nop 1
    v_permlane32_swap_b32 v126, v127
    v_add_f32 v126, v126, v127
    s_waitcnt lgkmcnt(4)
    v_mfma_f32_32x32x16_bf16 v[96:111], v[52:55], v[152:155], v[96:111]
    ds_read_b64_tr_b16 v[52:53], v77 offset:16384
    ds_read_b64_tr_b16 v[54:55], v77 offset:16896
    buffer_load_dwordx4 v65, s[4:7], s83 offen offset:1024 lds
    s_setprio 1
    v_mfma_f32_32x32x16_bf16 v[32:47], v[48:51], v[200:203], v[32:47]
    ds_read_b64_tr_b16 v[48:49], v72 offset:40960
    ds_read_b64_tr_b16 v[50:51], v72 offset:41472
    s_waitcnt lgkmcnt(6)
    v_mfma_f32_32x32x16_bf16 v[96:111], v[60:63], v[156:159], v[96:111]
    ds_read_b64_tr_b16 v[60:61], v77 offset:18432
    ds_read_b64_tr_b16 v[62:63], v77 offset:18944
    buffer_load_dwordx4 v66, s[4:7], s83 offen offset:2048 lds
    s_waitcnt lgkmcnt(6)
    v_mfma_f32_32x32x16_bf16 v[32:47], v[56:59], v[204:207], v[32:47]
    s_waitcnt vmcnt(5)
    ds_read_b128 v[208:211], v68 offset:8192
    ds_read_b128 v[212:215], v69 offset:8192
    ds_read_b128 v[216:219], v70 offset:8192
    ds_read_b128 v[220:223], v71 offset:8192
    ds_read_b64_tr_b16 v[56:57], v72 offset:43008
    ds_read_b64_tr_b16 v[58:59], v72 offset:43520
    buffer_load_dwordx4 v67, s[4:7], s83 offen offset:3072 lds
    s_waitcnt lgkmcnt(10)
    v_mfma_f32_32x32x16_bf16 v[96:111], v[52:55], v[160:163], v[96:111]
    ds_read_b64_tr_b16 v[52:53], v77 offset:20480
    ds_read_b64_tr_b16 v[54:55], v77 offset:20992
    s_setprio 0
    s_waitcnt lgkmcnt(7)
    v_mfma_f32_32x32x16_bf16 v[32:47], v[48:51], v[208:211], v[32:47]
    ds_read_b64_tr_b16 v[48:49], v72 offset:45056
    ds_read_b64_tr_b16 v[50:51], v72 offset:45568
    v_mfma_f32_32x32x16_bf16 v[96:111], v[60:63], v[164:167], v[96:111]
    ds_read_b64_tr_b16 v[60:61], v77 offset:22528
    ds_read_b64_tr_b16 v[62:63], v77 offset:23040
    s_add_u32 s3, s55, 7
    s_and_b32 s3, s3, 7
    s_lshl_b32 s3, s3, 7
    s_add_u32 m0, s58, 4096
    s_add_u32 s83, s3, s61
    buffer_load_dwordx4 v64, s[4:7], s83 offen lds
    s_waitcnt lgkmcnt(6)
    v_mfma_f32_32x32x16_bf16 v[32:47], v[56:59], v[212:215], v[32:47]
    ds_read_b64_tr_b16 v[56:57], v72 offset:47104
    ds_read_b64_tr_b16 v[58:59], v72 offset:47616
    s_waitcnt lgkmcnt(6)
    v_mfma_f32_32x32x16_bf16 v[96:111], v[52:55], v[168:171], v[96:111]
    ds_read_b64_tr_b16 v[52:53], v77 offset:24576
    ds_read_b64_tr_b16 v[54:55], v77 offset:25088
    s_waitcnt lgkmcnt(4)
    v_mfma_f32_32x32x16_bf16 v[96:111], v[60:63], v[172:175], v[96:111]
    ds_read_b64_tr_b16 v[60:61], v77 offset:26624
    ds_read_b64_tr_b16 v[62:63], v77 offset:27136
    buffer_load_dwordx4 v65, s[4:7], s83 offen offset:1024 lds
    s_setprio 3
    v_mfma_f32_32x32x16_bf16 v[32:47], v[48:51], v[216:219], v[32:47]
    s_waitcnt vmcnt(6)
    s_barrier
    ds_read_b64_tr_b16 v[48:49], v72 offset:49152
    ds_read_b64_tr_b16 v[50:51], v72 offset:49664
    s_waitcnt lgkmcnt(4)
    v_mfma_f32_32x32x16_bf16 v[96:111], v[52:55], v[176:179], v[96:111]
    ds_read_b64_tr_b16 v[52:53], v77 offset:28672
    ds_read_b64_tr_b16 v[54:55], v77 offset:29184
    buffer_load_dwordx4 v66, s[4:7], s83 offen offset:2048 lds
    v_mfma_f32_32x32x16_bf16 v[32:47], v[56:59], v[220:223], v[32:47]
    s_waitcnt vmcnt(3)
    ds_read_b128 v[224:227], v68 offset:0
    ds_read_b128 v[228:231], v69 offset:0
    ds_read_b128 v[232:235], v70 offset:0
    ds_read_b128 v[236:239], v71 offset:0
    ds_read_b64_tr_b16 v[56:57], v72 offset:51200
    ds_read_b64_tr_b16 v[58:59], v72 offset:51712
    s_waitcnt lgkmcnt(10)
    v_mfma_f32_32x32x16_bf16 v[96:111], v[60:63], v[180:183], v[96:111]
    ds_read_b64_tr_b16 v[60:61], v77 offset:30720
    ds_read_b64_tr_b16 v[62:63], v77 offset:31232
    buffer_load_dwordx4 v67, s[4:7], s83 offen offset:3072 lds
    s_setprio 2
    s_waitcnt lgkmcnt(7)
    v_mfma_f32_32x32x16_bf16 v[32:47], v[48:51], v[224:227], v[32:47]
    ds_read_b64_tr_b16 v[48:49], v72 offset:53248
    ds_read_b64_tr_b16 v[50:51], v72 offset:53760
    v_mfma_f32_32x32x16_bf16 v[96:111], v[52:55], v[184:187], v[96:111]
    ds_read_b64_tr_b16 v[52:53], v77 offset:32768
    ds_read_b64_tr_b16 v[54:55], v77 offset:33280
    v_lshrrev_b32 v11, 2, v1
    s_mov_b64 exec, 0xf
    buffer_load_dword v11, v11, s[36:39], 0 offen sc1
    s_mov_b64 exec, -1
    s_waitcnt lgkmcnt(6)
    v_mfma_f32_32x32x16_bf16 v[32:47], v[56:59], v[228:231], v[32:47]
    ds_read_b64_tr_b16 v[56:57], v72 offset:55296
    ds_read_b64_tr_b16 v[58:59], v72 offset:55808
    s_waitcnt lgkmcnt(6)
    v_mfma_f32_32x32x16_bf16 v[96:111], v[60:63], v[188:191], v[96:111]
    ds_read_b64_tr_b16 v[60:61], v77 offset:34816
    ds_read_b64_tr_b16 v[62:63], v77 offset:35328
    s_add_u32 s63, s63, 8
    s_and_b32 s63, s63, 31
    s_mul_i32 s3, s63, 57344
    s_add_u32 m0, s58, 8192
    s_add_u32 s81, s3, s76
    buffer_load_dwordx4 v12, s[44:47], s81 offen lds
    s_setprio 1
    s_waitcnt lgkmcnt(6)
    v_mfma_f32_32x32x16_bf16 v[32:47], v[48:51], v[232:235], v[32:47]
    ds_read_b64_tr_b16 v[48:49], v72 offset:57344
    ds_read_b64_tr_b16 v[50:51], v72 offset:57856
    s_waitcnt lgkmcnt(6)
    v_mfma_f32_32x32x16_bf16 v[96:111], v[52:55], v[192:195], v[96:111]
    ds_read_b64_tr_b16 v[52:53], v77 offset:36864
    ds_read_b64_tr_b16 v[54:55], v77 offset:37376
    s_waitcnt lgkmcnt(4)
    v_mfma_f32_32x32x16_bf16 v[96:111], v[60:63], v[196:199], v[96:111]
    ds_read_b64_tr_b16 v[60:61], v77 offset:38912
    ds_read_b64_tr_b16 v[62:63], v77 offset:39424
    s_add_u32 s63, s63, 8
    s_and_b32 s63, s63, 31
    s_mul_i32 s3, s63, 57344
    s_add_u32 m0, s58, 9216
    s_add_u32 s81, s3, s76
    buffer_load_dwordx4 v12, s[44:47], s81 offen lds
    v_mfma_f32_32x32x16_bf16 v[32:47], v[56:59], v[236:239], v[32:47]
    s_waitcnt vmcnt(3)
    ds_read_b128 v[240:243], v68 offset:4096
    ds_read_b128 v[244:247], v69 offset:4096
    ds_read_b128 v[248:251], v70 offset:4096
    ds_read_b128 v[252:255], v71 offset:4096
    ds_read_b64_tr_b16 v[56:57], v72 offset:59392
    ds_read_b64_tr_b16 v[58:59], v72 offset:59904
    s_waitcnt lgkmcnt(8)
    v_mfma_f32_32x32x16_bf16 v[96:111], v[52:55], v[200:203], v[96:111]
    ds_read_b64_tr_b16 v[52:53], v77 offset:40960
    ds_read_b64_tr_b16 v[54:55], v77 offset:41472
    s_add_u32 s63, s63, 8
    s_and_b32 s63, s63, 31
    s_mul_i32 s3, s63, 57344
    s_add_u32 m0, s58, 10240
    s_add_u32 s81, s3, s76
    buffer_load_dwordx4 v12, s[44:47], s81 offen lds
    s_setprio 0
    s_waitcnt lgkmcnt(7)
    v_mfma_f32_32x32x16_bf16 v[32:47], v[48:51], v[240:243], v[32:47]
    ds_read_b64_tr_b16 v[48:49], v72 offset:61440
    ds_read_b64_tr_b16 v[50:51], v72 offset:61952
    v_mfma_f32_32x32x16_bf16 v[96:111], v[60:63], v[204:207], v[96:111]
    ds_read_b64_tr_b16 v[60:61], v77 offset:43008
    ds_read_b64_tr_b16 v[62:63], v77 offset:43520
    s_waitcnt lgkmcnt(6)
    v_mfma_f32_32x32x16_bf16 v[32:47], v[56:59], v[244:247], v[32:47]
    ds_read_b64_tr_b16 v[56:57], v72 offset:63488
    ds_read_b64_tr_b16 v[58:59], v72 offset:64000
    s_waitcnt lgkmcnt(6)
    v_mfma_f32_32x32x16_bf16 v[96:111], v[52:55], v[208:211], v[96:111]
    ds_read_b64_tr_b16 v[52:53], v77 offset:45056
    ds_read_b64_tr_b16 v[54:55], v77 offset:45568
    s_setprio 3
    s_waitcnt lgkmcnt(6)
    v_mfma_f32_32x32x16_bf16 v[32:47], v[48:51], v[248:251], v[32:47]
    s_waitcnt lgkmcnt(4)
    v_mfma_f32_32x32x16_bf16 v[96:111], v[60:63], v[212:215], v[96:111]
    ds_read_b64_tr_b16 v[60:61], v77 offset:47104
    ds_read_b64_tr_b16 v[62:63], v77 offset:47616
    s_add_u32 s63, s63, 8
    s_and_b32 s63, s63, 31
    s_mul_i32 s3, s63, 57344
    s_add_u32 m0, s58, 11264
    s_add_u32 s81, s3, s76
    buffer_load_dwordx4 v12, s[44:47], s81 offen lds
    s_waitcnt lgkmcnt(4)
    v_mfma_f32_32x32x16_bf16 v[32:47], v[56:59], v[252:255], v[32:47]
    s_waitcnt lgkmcnt(2)
    v_mfma_f32_32x32x16_bf16 v[96:111], v[52:55], v[216:219], v[96:111]
    ds_read_b64_tr_b16 v[52:53], v77 offset:49152
    ds_read_b64_tr_b16 v[54:55], v77 offset:49664
    s_waitcnt lgkmcnt(2)
    v_mfma_f32_32x32x16_bf16 v[96:111], v[60:63], v[220:223], v[96:111]
    ds_read_b64_tr_b16 v[60:61], v77 offset:51200
    ds_read_b64_tr_b16 v[62:63], v77 offset:51712
    s_cmp_eq_u32 s60, 0
    s_cbranch_scc1 L_r0
    s_cmp_eq_u32 s60, 3
    s_cbranch_scc1 L_r3
    s_waitcnt lgkmcnt(2)
    v_mfma_f32_32x32x16_bf16 v[96:111], v[52:55], v[224:227], v[96:111]
    ds_read_b64_tr_b16 v[52:53], v77 offset:53248
    ds_read_b64_tr_b16 v[54:55], v77 offset:53760
    s_waitcnt lgkmcnt(2)
    v_mfma_f32_32x32x16_bf16 v[96:111], v[60:63], v[228:231], v[96:111]
    ds_read_b64_tr_b16 v[60:61], v77 offset:55296
    ds_read_b64_tr_b16 v[62:63], v77 offset:55808
    v_cvt_pk_bf16_f32 v32, v32, v33
    v_cvt_pk_bf16_f32 v33, v34, v35
    s_waitcnt lgkmcnt(2)
    v_mfma_f32_32x32x16_bf16 v[96:111], v[52:55], v[232:235], v[96:111]
    ds_read_b64_tr_b16 v[52:53], v77 offset:57344
    ds_read_b64_tr_b16 v[54:55], v77 offset:57856
    v_cvt_pk_bf16_f32 v34, v36, v37
    v_cvt_pk_bf16_f32 v35, v38, v39
    s_waitcnt lgkmcnt(2)
    v_mfma_f32_32x32x16_bf16 v[96:111], v[60:63], v[236:239], v[96:111]
    ds_read_b64_tr_b16 v[60:61], v77 offset:59392
    ds_read_b64_tr_b16 v[62:63], v77 offset:59904
    buffer_store_dwordx4 v[32:35], v1, s[40:43], s69 offen sc1
    s_add_u32 s69, s69, 131072
    v_cvt_pk_bf16_f32 v40, v40, v41
    s_waitcnt lgkmcnt(2)
    v_mfma_f32_32x32x16_bf16 v[96:111], v[52:55], v[240:243], v[96:111]
    ds_read_b64_tr_b16 v[52:53], v77 offset:61440
    ds_read_b64_tr_b16 v[54:55], v77 offset:61952
    v_cvt_pk_bf16_f32 v41, v42, v43
    s_waitcnt lgkmcnt(2)
    v_mfma_f32_32x32x16_bf16 v[96:111], v[60:63], v[244:247], v[96:111]
    ds_read_b64_tr_b16 v[60:61], v77 offset:63488
    ds_read_b64_tr_b16 v[62:63], v77 offset:64000
    v_cvt_pk_bf16_f32 v42, v44, v45
    s_waitcnt lgkmcnt(2)
    v_mfma_f32_32x32x16_bf16 v[96:111], v[52:55], v[248:251], v[96:111]
    v_cvt_pk_bf16_f32 v43, v46, v47
    s_waitcnt lgkmcnt(0)
    v_mfma_f32_32x32x16_bf16 v[96:111], v[60:63], v[252:255], v[96:111]
    buffer_store_dwordx4 v[40:43], v1, s[40:43], s69 offen sc1
    s_add_u32 s69, s69, 131072
    s_waitcnt vmcnt(4)
    s_barrier
    ds_read_b64_tr_b16 v[112:113], v4 offset:8192
    ds_read_b64_tr_b16 v[114:115], v4 offset:8448
    ds_read_b64_tr_b16 v[116:117], v4 offset:20480
    ds_read_b64_tr_b16 v[118:119], v4 offset:20736
    s_setprio 3
    s_waitcnt lgkmcnt(2)
    v_mfma_f32_32x32x16_bf16 v[80:95], v[112:115], v[128:131], 0
    ds_read_b64_tr_b16 v[120:121], v4 offset:32768
    ds_read_b64_tr_b16 v[122:123], v4 offset:33024
    s_waitcnt lgkmcnt(2)
    v_mfma_f32_32x32x16_bf16 v[80:95], v[116:119], v[132:135], v[80:95]
    ds_read_b64_tr_b16 v[112:113], v4 offset:45056
    ds_read_b64_tr_b16 v[114:115], v4 offset:45312
    v_cvt_pk_bf16_f32 v96, v96, v97
    v_cvt_pk_bf16_f32 v97, v98, v99
    s_waitcnt lgkmcnt(2)
    v_mfma_f32_32x32x16_bf16 v[80:95], v[120:123], v[136:139], v[80:95]
    ds_read_b64_tr_b16 v[116:117], v5 offset:8192
    ds_read_b64_tr_b16 v[118:119], v5 offset:8448
    v_cvt_pk_bf16_f32 v98, v100, v101
    s_waitcnt lgkmcnt(2)
    v_mfma_f32_32x32x16_bf16 v[80:95], v[112:115], v[140:143], v[80:95]
    ds_read_b64_tr_b16 v[120:121], v5 offset:20480
    ds_read_b64_tr_b16 v[122:123], v5 offset:20736
    v_cvt_pk_bf16_f32 v99, v102, v103
    s_setprio 2
    s_waitcnt lgkmcnt(2)
    v_mfma_f32_32x32x16_bf16 v[80:95], v[116:119], v[144:147], v[80:95]
    ds_read_b64_tr_b16 v[112:113], v5 offset:32768
    ds_read_b64_tr_b16 v[114:115], v5 offset:33024
    buffer_store_dwordx4 v[96:99], v1, s[40:43], s69 offen sc1
    s_add_u32 s69, s69, 131072
    v_cvt_pk_bf16_f32 v104, v104, v105
    v_cvt_pk_bf16_f32 v105, v106, v107
    s_waitcnt lgkmcnt(2)
    v_mfma_f32_32x32x16_bf16 v[80:95], v[120:123], v[148:151], v[80:95]
    ds_read_b64_tr_b16 v[116:117], v5 offset:45056
    ds_read_b64_tr_b16 v[118:119], v5 offset:45312
    v_lshrrev_b32 v10, 2, v1
    s_mov_b32 exec_hi, 0
    buffer_store_dword v126, v10, s[40:43], s68 offen sc1
    s_mov_b64 exec, -1
    s_and_b32 s68, s68, 0xfffffc00
    v_cvt_pk_bf16_f32 v106, v108, v109
    v_cvt_pk_bf16_f32 v107, v110, v111
    s_waitcnt lgkmcnt(2)
    v_mfma_f32_32x32x16_bf16 v[80:95], v[112:115], v[152:155], v[80:95]
    ds_read_b64_tr_b16 v[120:121], v4 offset:9216
    ds_read_b64_tr_b16 v[122:123], v4 offset:9472
    buffer_store_dwordx4 v[104:107], v1, s[40:43], s69 offen sc1
    s_waitcnt lgkmcnt(2)
    v_mfma_f32_32x32x16_bf16 v[80:95], v[116:119], v[156:159], v[80:95]
    ds_read_b64_tr_b16 v[112:113], v4 offset:21504
    ds_read_b64_tr_b16 v[114:115], v4 offset:21760
    s_setprio 1
    s_waitcnt lgkmcnt(2)
    v_mfma_f32_32x32x16_bf16 v[80:95], v[120:123], v[160:163], v[80:95]
    ds_read_b64_tr_b16 v[116:117], v4 offset:33792
    ds_read_b64_tr_b16 v[118:119], v4 offset:34048
    v_mov_b32 v64, 0
    s_waitcnt lgkmcnt(2)
    v_mfma_f32_32x32x16_bf16 v[80:95], v[112:115], v[164:167], v[80:95]
    ds_read_b64_tr_b16 v[120:121], v4 offset:46080
    ds_read_b64_tr_b16 v[122:123], v4 offset:46336
    v_mov_b32 v65, 0
    s_waitcnt lgkmcnt(2)
    v_mfma_f32_32x32x16_bf16 v[80:95], v[116:119], v[168:171], v[80:95]
    ds_read_b64_tr_b16 v[112:113], v5 offset:9216
    ds_read_b64_tr_b16 v[114:115], v5 offset:9472
    v_mov_b32 v66, 0
    s_waitcnt lgkmcnt(2)
    v_mfma_f32_32x32x16_bf16 v[80:95], v[120:123], v[172:175], v[80:95]
    ds_read_b64_tr_b16 v[116:117], v5 offset:21504
    ds_read_b64_tr_b16 v[118:119], v5 offset:21760
    s_setprio 0
    s_waitcnt lgkmcnt(2)
    v_mfma_f32_32x32x16_bf16 v[80:95], v[112:115], v[176:179], v[80:95]
    ds_read_b64_tr_b16 v[120:121], v5 offset:33792
    ds_read_b64_tr_b16 v[122:123], v5 offset:34048
    v_mov_b32 v67, 0
    s_waitcnt lgkmcnt(2)
    v_mfma_f32_32x32x16_bf16 v[80:95], v[116:119], v[180:183], v[80:95]
    ds_read_b64_tr_b16 v[112:113], v5 offset:46080
    ds_read_b64_tr_b16 v[114:115], v5 offset:46336
    s_add_u32 s63, s63, 8
    s_and_b32 s63, s63, 31
    s_mul_i32 s3, s63, 57344
    s_mov_b32 m0, s58
    s_add_u32 s81, s3, s65
    buffer_load_dwordx4 v12, s[20:23], s81 offen lds
    v_mov_b32 v68, 0
    s_waitcnt lgkmcnt(2)
    v_mfma_f32_32x32x16_bf16 v[80:95], v[120:123], v[184:187], v[80:95]
    s_waitcnt vmcnt(6)
    s_barrier
    ds_read_b64_tr_b16 v[116:117], v4 offset:10240
    ds_read_b64_tr_b16 v[118:119], v4 offset:10496
    v_cmp_gt_u32 vcc, 0x80, v11
    s_nop 0
    s_and_b32 s3, vcc_lo, 0xf
    s_cbranch_scc1 L_init_s_7
L_init_b_6:
    v_mov_b32 v69, 0
    s_waitcnt lgkmcnt(2)
    v_mfma_f32_32x32x16_bf16 v[80:95], v[112:115], v[188:191], v[80:95]
    ds_read_b64_tr_b16 v[120:121], v4 offset:22528
    ds_read_b64_tr_b16 v[122:123], v4 offset:22784
    s_setprio 3
    s_waitcnt lgkmcnt(2)
    v_mfma_f32_32x32x16_bf16 v[80:95], v[116:119], v[192:195], v[80:95]
    ds_read_b64_tr_b16 v[112:113], v4 offset:34816
    ds_read_b64_tr_b16 v[114:115], v4 offset:35072
    s_waitcnt vmcnt(1)
    s_mov_b64 exec, 2
    buffer_atomic_add v1, off, s[40:43], s71 offset:0 sc1
    s_mov_b64 exec, -1
    v_mov_b32 v70, 0
    s_waitcnt lgkmcnt(2)
    v_mfma_f32_32x32x16_bf16 v[80:95], v[120:123], v[196:199], v[80:95]
    ds_read_b64_tr_b16 v[116:117], v4 offset:47104
    ds_read_b64_tr_b16 v[118:119], v4 offset:47360
    v_mov_b32 v71, 0
    s_waitcnt lgkmcnt(2)
    v_mfma_f32_32x32x16_bf16 v[80:95], v[112:115], v[200:203], v[80:95]
    ds_read_b64_tr_b16 v[120:121], v5 offset:10240
    ds_read_b64_tr_b16 v[122:123], v5 offset:10496
    v_mov_b32 v72, 0
    s_waitcnt lgkmcnt(2)
    v_mfma_f32_32x32x16_bf16 v[80:95], v[116:119], v[204:207], v[80:95]
    ds_read_b64_tr_b16 v[112:113], v5 offset:22528
    ds_read_b64_tr_b16 v[114:115], v5 offset:22784
    s_setprio 2
    s_waitcnt lgkmcnt(2)
    v_mfma_f32_32x32x16_bf16 v[80:95], v[120:123], v[208:211], v[80:95]
    ds_read_b64_tr_b16 v[116:117], v5 offset:34816
    ds_read_b64_tr_b16 v[118:119], v5 offset:35072
    v_lshrrev_b32 v6, 2, v1
    v_mov_b32 v7, 0
    ds_write2st64_b32 v6, v7, v7 offset0:194 offset1:195
    s_add_u32 s63, s63, 8
    s_and_b32 s63, s63, 31
    s_mul_i32 s3, s63, 57344
    s_add_u32 m0, s58, 1024
    s_add_u32 s81, s3, s65
    buffer_load_dwordx4 v12, s[20:23], s81 offen lds
    v_mov_b32 v73, 0
    s_waitcnt lgkmcnt(3)
    v_mfma_f32_32x32x16_bf16 v[80:95], v[112:115], v[212:215], v[80:95]
    ds_read_b64_tr_b16 v[120:121], v5 offset:47104
    ds_read_b64_tr_b16 v[122:123], v5 offset:47360
    v_mov_b32 v74, 0
    s_waitcnt lgkmcnt(3)
    v_mfma_f32_32x32x16_bf16 v[80:95], v[116:119], v[216:219], v[80:95]
    ds_read_b64_tr_b16 v[112:113], v4 offset:11264
    ds_read_b64_tr_b16 v[114:115], v4 offset:11520
    v_mov_b32 v75, 0
    s_waitcnt lgkmcnt(2)
    v_mfma_f32_32x32x16_bf16 v[80:95], v[120:123], v[220:223], v[80:95]
    ds_read_b64_tr_b16 v[116:117], v4 offset:23552
    ds_read_b64_tr_b16 v[118:119], v4 offset:23808
    s_setprio 1
    s_waitcnt lgkmcnt(2)
    v_mfma_f32_32x32x16_bf16 v[80:95], v[112:115], v[224:227], v[80:95]
    ds_read_b64_tr_b16 v[120:121], v4 offset:35840
    ds_read_b64_tr_b16 v[122:123], v4 offset:36096
    v_mov_b32 v76, 0
    s_waitcnt lgkmcnt(2)
    v_mfma_f32_32x32x16_bf16 v[80:95], v[116:119], v[228:231], v[80:95]
    ds_read_b64_tr_b16 v[112:113], v4 offset:48128
    ds_read_b64_tr_b16 v[114:115], v4 offset:48384
    v_mov_b32 v77, 0
    s_waitcnt lgkmcnt(2)
    v_mfma_f32_32x32x16_bf16 v[80:95], v[120:123], v[232:235], v[80:95]
    ds_read_b64_tr_b16 v[116:117], v5 offset:11264
    ds_read_b64_tr_b16 v[118:119], v5 offset:11520
    v_mov_b32 v78, 0
    s_waitcnt lgkmcnt(2)
    v_mfma_f32_32x32x16_bf16 v[80:95], v[112:115], v[236:239], v[80:95]
    ds_read_b64_tr_b16 v[120:121], v5 offset:23552
    ds_read_b64_tr_b16 v[122:123], v5 offset:23808
    s_setprio 0
    s_waitcnt lgkmcnt(2)
    v_mfma_f32_32x32x16_bf16 v[80:95], v[116:119], v[240:243], v[80:95]
    ds_read_b64_tr_b16 v[112:113], v5 offset:35840
    ds_read_b64_tr_b16 v[114:115], v5 offset:36096
    v_mov_b32 v79, 0
    s_waitcnt lgkmcnt(2)
    v_mfma_f32_32x32x16_bf16 v[80:95], v[120:123], v[244:247], v[80:95]
    ds_read_b64_tr_b16 v[116:117], v5 offset:48128
    ds_read_b64_tr_b16 v[118:119], v5 offset:48384
    s_add_u32 s63, s63, 8
    s_and_b32 s63, s63, 31
    s_mul_i32 s3, s63, 57344
    s_add_u32 m0, s58, 2048
    s_add_u32 s81, s3, s65
    buffer_load_dwordx4 v12, s[20:23], s81 offen lds
    v_mov_b32 v0, 0xdddddddd
    s_waitcnt lgkmcnt(2)
    v_mfma_f32_32x32x16_bf16 v[80:95], v[112:115], v[248:251], v[80:95]
    s_waitcnt vmcnt(1)
    s_barrier
    ds_read_b64_tr_b16 v[120:121], v4 offset:0
    ds_read_b64_tr_b16 v[122:123], v4 offset:256
    v_mov_b32 v11, 0
    s_mov_b64 exec, 0x1
    buffer_atomic_or v11, v13, s[40:43], s71 offen offset:0 sc0 sc1
    s_mov_b64 exec, -1
    s_waitcnt lgkmcnt(2)
    v_mfma_f32_32x32x16_bf16 v[80:95], v[116:119], v[252:255], v[80:95]
    ds_read_b64_tr_b16 v[112:113], v4 offset:12288
    ds_read_b64_tr_b16 v[114:115], v4 offset:12544
    s_add_u32 s63, s63, 8
    s_and_b32 s63, s63, 31
    s_mul_i32 s3, s63, 57344
    s_add_u32 m0, s58, 3072
    s_add_u32 s81, s3, s65
    buffer_load_dwordx4 v12, s[20:23], s81 offen lds
    s_setprio 3
    s_waitcnt lgkmcnt(2)
    v_mfma_f32_32x32x16_bf16 v[96:111], v[120:123], v[128:131], 0
    ds_read_b64_tr_b16 v[116:117], v4 offset:24576
    ds_read_b64_tr_b16 v[118:119], v4 offset:24832
    s_waitcnt lgkmcnt(2)
    v_mfma_f32_32x32x16_bf16 v[96:111], v[112:115], v[132:135], v[96:111]
    ds_read_b64_tr_b16 v[120:121], v4 offset:36864
    ds_read_b64_tr_b16 v[122:123], v4 offset:37120
    s_waitcnt lgkmcnt(2)
    v_mfma_f32_32x32x16_bf16 v[96:111], v[116:119], v[136:139], v[96:111]
    ds_read_b64_tr_b16 v[112:113], v5 offset:0
    ds_read_b64_tr_b16 v[114:115], v5 offset:256
    v_mul_f32 v80, 0xbfb8aa3b, v80
    v_mul_f32 v81, 0xbfb8aa3b, v81
    v_mul_f32 v82, 0xbfb8aa3b, v82
    v_mul_f32 v83, 0xbfb8aa3b, v83
    v_exp_f32 v80, v80
    s_waitcnt lgkmcnt(2)
    v_mfma_f32_32x32x16_bf16 v[96:111], v[120:123], v[140:143], v[96:111]
    ds_read_b64_tr_b16 v[116:117], v5 offset:12288
    ds_read_b64_tr_b16 v[118:119], v5 offset:12544
    v_exp_f32 v81, v81
    v_exp_f32 v82, v82
    v_exp_f32 v83, v83
    v_mul_f32 v84, 0xbfb8aa3b, v84
    v_mul_f32 v85, 0xbfb8aa3b, v85
    s_setprio 2
    s_waitcnt lgkmcnt(2)
    v_mfma_f32_32x32x16_bf16 v[96:111], v[112:115], v[144:147], v[96:111]
    ds_read_b64_tr_b16 v[120:121], v5 offset:24576
    ds_read_b64_tr_b16 v[122:123], v5 offset:24832
    v_mul_f32 v86, 0xbfb8aa3b, v86
    v_mul_f32 v87, 0xbfb8aa3b, v87
    v_exp_f32 v84, v84
    v_exp_f32 v85, v85
    v_exp_f32 v86, v86
    s_waitcnt lgkmcnt(2)
    v_mfma_f32_32x32x16_bf16 v[96:111], v[116:119], v[148:151], v[96:111]
    ds_read_b64_tr_b16 v[112:113], v5 offset:36864
    ds_read_b64_tr_b16 v[114:115], v5 offset:37120
    v_exp_f32 v87, v87
    v_mul_f32 v88, 0xbfb8aa3b, v88
    v_mul_f32 v89, 0xbfb8aa3b, v89
    v_mul_f32 v90, 0xbfb8aa3b, v90
    s_waitcnt lgkmcnt(2)
    v_mfma_f32_32x32x16_bf16 v[96:111], v[120:123], v[152:155], v[96:111]
    ds_read_b64_tr_b16 v[116:117], v4 offset:1024
    ds_read_b64_tr_b16 v[118:119], v4 offset:1280
    s_waitcnt vmcnt(1)
    v_cmp_gt_u32 vcc, 0x80, v11
    s_nop 0
    s_and_b32 s3, vcc_lo, 0x1
    s_cbranch_scc1 L_kp0_s_9
L_kp0_b_8:
    s_mov_b32 m0, s62
    s_add_u32 s82, s54, 0
    s_and_b32 s82, s82, 7
    s_lshl_b32 s82, s82, 14
    s_add_u32 s69, s82, s70
    buffer_load_dwordx4 v1, s[40:43], s69 offen sc1 lds
    v_mul_f32 v91, 0xbfb8aa3b, v91
    v_exp_f32 v88, v88
    v_exp_f32 v89, v89
    v_exp_f32 v90, v90
    v_exp_f32 v91, v91
    s_waitcnt lgkmcnt(2)
    v_mfma_f32_32x32x16_bf16 v[96:111], v[112:115], v[156:159], v[96:111]
    ds_read_b64_tr_b16 v[120:121], v4 offset:13312
    ds_read_b64_tr_b16 v[122:123], v4 offset:13568
    buffer_load_dwordx4 v[16:19], v1, s[40:43], s79 offen sc1
    v_mul_f32 v92, 0xbfb8aa3b, v92
    v_mul_f32 v93, 0xbfb8aa3b, v93
    v_mul_f32 v94, 0xbfb8aa3b, v94
    v_mul_f32 v95, 0xbfb8aa3b, v95
    v_exp_f32 v92, v92
    s_setprio 1
    s_waitcnt lgkmcnt(2)
    v_mfma_f32_32x32x16_bf16 v[96:111], v[116:119], v[160:163], v[96:111]
    ds_read_b64_tr_b16 v[112:113], v4 offset:25600
    ds_read_b64_tr_b16 v[114:115], v4 offset:25856
    buffer_load_dwordx4 v1, s[40:43], s69 offen offset:1024 sc1 lds
    v_exp_f32 v93, v93
    v_exp_f32 v94, v94
    v_exp_f32 v95, v95
L_join:
    s_waitcnt lgkmcnt(2)
    v_mfma_f32_32x32x16_bf16 v[96:111], v[120:123], v[164:167], v[96:111]
    ds_read_b64_tr_b16 v[116:117], v4 offset:37888
    ds_read_b64_tr_b16 v[118:119], v4 offset:38144
    buffer_load_dword v20, v10, s[40:43], s68 offen offset:0 sc1
    buffer_load_dword v21, v10, s[40:43], s68 offen offset:256 sc1
    v_add_f32 v80, 1.0, v80
    v_add_f32 v81, 1.0, v81
    v_add_f32 v82, 1.0, v82
    s_waitcnt lgkmcnt(2)
    v_mfma_f32_32x32x16_bf16 v[96:111], v[112:115], v[168:171], v[96:111]
    ds_read_b64_tr_b16 v[120:121], v5 offset:1024
    ds_read_b64_tr_b16 v[122:123], v5 offset:1280
    buffer_load_dword v22, v10, s[40:43], s68 offen offset:512 sc1
    buffer_load_dword v23, v10, s[40:43], s68 offen offset:768 sc1
    v_add_f32 v83, 1.0, v83
    v_rcp_f32 v80, v80
    s_waitcnt lgkmcnt(2)
    v_mfma_f32_32x32x16_bf16 v[96:111], v[116:119], v[172:175], v[96:111]
    ds_read_b64_tr_b16 v[112:113], v5 offset:13312
    ds_read_b64_tr_b16 v[114:115], v5 offset:13568
    s_add_u32 s82, s71, 0x8000
    s_and_b32 s82, s82, 0x3ffff
    v_mov_b32 v11, 0
    s_mov_b64 exec, 0x1
    buffer_atomic_or v11, v13, s[40:43], s82 offen offset:0 sc0 sc1
    s_mov_b64 exec, -1
    v_rcp_f32 v81, v81
    v_rcp_f32 v82, v82
    v_rcp_f32 v83, v83
    s_setprio 0
    s_waitcnt lgkmcnt(2)
    v_mfma_f32_32x32x16_bf16 v[96:111], v[120:123], v[176:179], v[96:111]
    ds_read_b64_tr_b16 v[116:117], v5 offset:25600
    ds_read_b64_tr_b16 v[118:119], v5 offset:25856
    v_add_f32 v84, 1.0, v84
    v_add_f32 v85, 1.0, v85
    s_waitcnt lgkmcnt(2)
    v_mfma_f32_32x32x16_bf16 v[96:111], v[112:115], v[180:183], v[96:111]
    ds_read_b64_tr_b16 v[120:121], v5 offset:37888
    ds_read_b64_tr_b16 v[122:123], v5 offset:38144
    v_add_f32 v86, 1.0, v86
    v_add_f32 v87, 1.0, v87
    v_rcp_f32 v84, v84
    s_waitcnt lgkmcnt(2)
    v_mfma_f32_32x32x16_bf16 v[96:111], v[116:119], v[184:187], v[96:111]
    s_waitcnt vmcnt(8)
    s_barrier
    ds_read_b64_tr_b16 v[112:113], v4 offset:2048
    ds_read_b64_tr_b16 v[114:115], v4 offset:2304
    v_rcp_f32 v85, v85
    v_rcp_f32 v86, v86
    s_waitcnt lgkmcnt(2)
    v_mfma_f32_32x32x16_bf16 v[96:111], v[120:123], v[188:191], v[96:111]
    ds_read_b64_tr_b16 v[116:117], v4 offset:14336
    ds_read_b64_tr_b16 v[118:119], v4 offset:14592
    v_rcp_f32 v87, v87
    v_add_f32 v88, 1.0, v88
    v_add_f32 v89, 1.0, v89
    s_setprio 3
    s_waitcnt lgkmcnt(2)
    v_mfma_f32_32x32x16_bf16 v[96:111], v[112:115], v[192:195], v[96:111]
    ds_read_b64_tr_b16 v[120:121], v4 offset:26624
    ds_read_b64_tr_b16 v[122:123], v4 offset:26880
    v_add_f32 v90, 1.0, v90
    v_add_f32 v91, 1.0, v91
    s_waitcnt lgkmcnt(2)
    v_mfma_f32_32x32x16_bf16 v[96:111], v[116:119], v[196:199], v[96:111]
    ds_read_b64_tr_b16 v[112:113], v4 offset:38912
    ds_read_b64_tr_b16 v[114:115], v4 offset:39168
    v_rcp_f32 v88, v88
    v_rcp_f32 v89, v89
    v_rcp_f32 v90, v90
    s_waitcnt lgkmcnt(2)
    v_mfma_f32_32x32x16_bf16 v[96:111], v[120:123], v[200:203], v[96:111]
    ds_read_b64_tr_b16 v[116:117], v5 offset:2048
    ds_read_b64_tr_b16 v[118:119], v5 offset:2304
    v_lshlrev_b32 v6, 3, v1
    s_and_b32 s3, s2, 1
    s_lshl_b32 s3, s3, 8
    s_add_u32 s3, s3, s52
    s_and_b32 s0, s2, 0xf8
    s_add_u32 s3, s3, s0
    s_lshr_b32 s0, s53, 3
    s_lshl2_add_u32 s3, s3, s0
    s_mul_i32 s3, s3, 896
    s_add_u32 m0, s62, 50176
    s_mov_b64 exec, 96
    buffer_load_dword v6, s[20:23], s3 offen lds
    s_mov_b64 exec, 96
    buffer_load_dword v6, s[16:19], s3 offen lds
    s_mov_b64 exec, -1
    v_rcp_f32 v91, v91
    v_add_f32 v92, 1.0, v92
    s_waitcnt lgkmcnt(2)
    v_mfma_f32_32x32x16_bf16 v[96:111], v[112:115], v[204:207], v[96:111]
    ds_read_b64_tr_b16 v[120:121], v5 offset:14336
    ds_read_b64_tr_b16 v[122:123], v5 offset:14592
    v_add_f32 v93, 1.0, v93
    v_add_f32 v94, 1.0, v94
    v_add_f32 v95, 1.0, v95
    s_setprio 2
    s_waitcnt lgkmcnt(2)
    v_mfma_f32_32x32x16_bf16 v[96:111], v[116:119], v[208:211], v[96:111]
    ds_read_b64_tr_b16 v[112:113], v5 offset:26624
    ds_read_b64_tr_b16 v[114:115], v5 offset:26880
    v_rcp_f32 v92, v92
    v_rcp_f32 v93, v93
    s_waitcnt lgkmcnt(2)
    v_mfma_f32_32x32x16_bf16 v[96:111], v[120:123], v[212:215], v[96:111]
    ds_read_b64_tr_b16 v[116:117], v5 offset:38912
    ds_read_b64_tr_b16 v[118:119], v5 offset:39168
    v_rcp_f32 v94, v94
    v_rcp_f32 v95, v95
    s_waitcnt lgkmcnt(2)
    v_mfma_f32_32x32x16_bf16 v[96:111], v[112:115], v[216:219], v[96:111]
    ds_read_b64_tr_b16 v[120:121], v4 offset:3072
    ds_read_b64_tr_b16 v[122:123], v4 offset:3328
    v_lshrrev_b32 v124, 2, v1
    v_and_b32 v124, 64, v124
    s_waitcnt lgkmcnt(2)
    v_mfma_f32_32x32x16_bf16 v[96:111], v[116:119], v[220:223], v[96:111]
    ds_read_b64_tr_b16 v[112:113], v4 offset:15360
    ds_read_b64_tr_b16 v[114:115], v4 offset:15616
    v_xor_b32 v124, v124, v1
    v_and_b32 v124, 0x70, v124
    v_lshrrev_b32 v12, 7, v1
    s_setprio 1
    s_waitcnt lgkmcnt(2)
    v_mfma_f32_32x32x16_bf16 v[96:111], v[120:123], v[224:227], v[96:111]
    ds_read_b64_tr_b16 v[116:117], v4 offset:27648
    ds_read_b64_tr_b16 v[118:119], v4 offset:27904
    v_lshl_add_u32 v12, v12, 10, v124
    v_add_u32 v124, 7168, v12
    s_waitcnt lgkmcnt(2)
    v_mfma_f32_32x32x16_bf16 v[96:111], v[112:115], v[228:231], v[96:111]
    ds_read_b64_tr_b16 v[120:121], v4 offset:39936
    ds_read_b64_tr_b16 v[122:123], v4 offset:40192
    s_waitcnt vmcnt(3)
    v_add_f32 v20, v20, v21
    v_add_f32 v22, v22, v23
    v_add_f32 v126, v20, v22
    v_mov_b32 v127, v126
    s_nop 1
    v_permlane32_swap_b32 v126, v127
    s_waitcnt lgkmcnt(2)
    v_mfma_f32_32x32x16_bf16 v[96:111], v[116:119], v[232:235], v[96:111]
    ds_read_b64_tr_b16 v[112:113], v5 offset:3072
    ds_read_b64_tr_b16 v[114:115], v5 offset:3328
    v_add_f32 v126, v126, v127
    v_mul_f32 v126, 0x3fb8aa3b, v126
    v_exp_f32 v6, v126
    s_waitcnt lgkmcnt(2)
    v_mfma_f32_32x32x16_bf16 v[96:111], v[120:123], v[236:239], v[96:111]
    ds_read_b64_tr_b16 v[116:117], v5 offset:15360
    ds_read_b64_tr_b16 v[118:119], v5 offset:15616
    v_exp_f32 v7, -v126
    v_add_f32 v6, 1.0, v6
    v_add_f32 v7, 1.0, v7
    s_setprio 0
    s_waitcnt lgkmcnt(2)
    v_mfma_f32_32x32x16_bf16 v[96:111], v[112:115], v[240:243], v[96:111]
    ds_read_b64_tr_b16 v[120:121], v5 offset:27648
    ds_read_b64_tr_b16 v[122:123], v5 offset:27904
    s_barrier
    ds_read_b128 v[20:23], v1 offset:0
    v_rcp_f32 v126, v6
    v_rcp_f32 v7, v7
    v_min_f32 v6, 0x71800000, v6
    s_waitcnt lgkmcnt(3)
    v_mfma_f32_32x32x16_bf16 v[96:111], v[116:119], v[244:247], v[96:111]
    ds_read_b64_tr_b16 v[112:113], v5 offset:39936
    ds_read_b64_tr_b16 v[114:115], v5 offset:40192
    v_pk_mul_f32 v[80:81], v[80:81], v[126:127] op_sel_hi:[1,0]
    v_pk_mul_f32 v[82:83], v[82:83], v[126:127] op_sel_hi:[1,0]
    v_pk_mul_f32 v[84:85], v[84:85], v[126:127] op_sel_hi:[1,0]
    s_waitcnt lgkmcnt(3)
    v_mfma_f32_32x32x16_bf16 v[96:111], v[120:123], v[248:251], v[96:111]
    s_add_u32 m0, s58, 4096
    s_nop 0
    buffer_load_dwordx4 v125, s[16:19], s77 offen lds
    s_waitcnt lgkmcnt(2)
    v_mfma_f32_32x32x16_bf16 v[48:63], v[20:23], v[16:19], 0
    ds_read_b128 v[20:23], v1 offset:2048
    v_pk_mul_f32 v[86:87], v[86:87], v[126:127] op_sel_hi:[1,0]
    v_pk_mul_f32 v[88:89], v[88:89], v[126:127] op_sel_hi:[1,0]
    v_pk_mul_f32 v[90:91], v[90:91], v[126:127] op_sel_hi:[1,0]
    s_waitcnt lgkmcnt(1)
    v_mfma_f32_32x32x16_bf16 v[96:111], v[112:115], v[252:255], v[96:111]
    v_pk_mul_f32 v[92:93], v[92:93], v[126:127] op_sel_hi:[1,0]
    v_pk_mul_f32 v[94:95], v[94:95], v[126:127] op_sel_hi:[1,0]
    s_lshl_b32 s3, s1, 11
    s_add_u32 s61, s3, s78
    s_add_u32 s68, s61, 28672
    s_cmp_eq_u32 s60, 3
    s_cbranch_scc0 L_join2
    v_pk_mul_f32 v[32:33], v[32:33], v[126:127] op_sel_hi:[1,0]
    v_pk_mul_f32 v[34:35], v[34:35], v[126:127] op_sel_hi:[1,0]
    v_pk_mul_f32 v[36:37], v[36:37], v[126:127] op_sel_hi:[1,0]
    v_pk_mul_f32 v[38:39], v[38:39], v[126:127] op_sel_hi:[1,0]
    v_pk_mul_f32 v[40:41], v[40:41], v[126:127] op_sel_hi:[1,0]
    v_pk_mul_f32 v[42:43], v[42:43], v[126:127] op_sel_hi:[1,0]
    v_pk_mul_f32 v[44:45], v[44:45], v[126:127] op_sel_hi:[1,0]
    v_pk_mul_f32 v[46:47], v[46:47], v[126:127] op_sel_hi:[1,0]
    v_cvt_pk_bf16_f32 v32, v32, v33
    v_cvt_pk_bf16_f32 v33, v34, v35
    v_cvt_pk_bf16_f32 v34, v36, v37
    v_cvt_pk_bf16_f32 v35, v38, v39
    v_cvt_pk_bf16_f32 v36, v40, v41
    v_cvt_pk_bf16_f32 v37, v42, v43
    v_cvt_pk_bf16_f32 v38, v44, v45
    v_cvt_pk_bf16_f32 v39, v46, v47
    s_sub_u32 s3, s61, 2048
    buffer_store_dwordx4 v[32:35], v1, s[40:43], s3 offen sc1
    s_sub_u32 s3, s68, 2048
    buffer_store_dwordx4 v[36:39], v1, s[40:43], s3 offen sc1
L_join2:
    s_mov_b32 s64, 0xffff
    s_mov_b32 s65, 0xffff
    s_setprio 3
    v_exp_f32 v48, v48
    s_mov_b64 exec, s[64:65]
    ds_read_b128 v[24:27], v2 offset:0
    ds_read_b128 v[28:31], v2 offset:256
    s_mov_b64 exec, -1
    s_waitcnt vmcnt(3)
    v_cmp_gt_u32 vcc, 0x80, v11
    s_nop 0
    s_and_b32 s3, vcc_lo, 0x1
    s_cbranch_scc1 L_kp1_s_28
L_kp1_b_27:
    s_add_u32 m0, s62, 16384
    s_add_u32 s82, s54, 1
    s_and_b32 s82, s82, 7
    s_lshl_b32 s82, s82, 14
    s_add_u32 s69, s82, s70
    buffer_load_dwordx4 v1, s[40:43], s69 offen sc1 lds
    v_exp_f32 v49, v49
    v_exp_f32 v50, v50
    v_exp_f32 v51, v51
    v_exp_f32 v52, v52
    s_waitcnt lgkmcnt(2)
    v_mfma_f32_32x32x16_bf16 v[32:47], v[20:23], v[16:19], 0
    ds_read_b128 v[20:23], v1 offset:4096
    buffer_load_dwordx4 v1, s[40:43], s69 offen offset:1024 sc1 lds
    v_exp_f32 v53, v53
    v_exp_f32 v54, v54
    v_exp_f32 v55, v55
    v_pk_mul_f32 v[96:97], v[80:81], v[96:97]
    v_exp_f32 v56, v56
    v_pk_mul_f32 v[98:99], v[82:83], v[98:99]
    v_exp_f32 v57, v57
    v_pk_mul_f32 v[100:101], v[84:85], v[100:101]
    v_exp_f32 v58, v58
    s_waitcnt lgkmcnt(2)
    v_smfmac_f32_32x32x32_bf16 v[64:79], v[24:27], v[48:55], v0
    v_pk_mul_f32 v[102:103], v[86:87], v[102:103]
    v_exp_f32 v59, v59
    v_pk_mul_f32 v[104:105], v[88:89], v[104:105]
    v_exp_f32 v60, v60
    v_pk_mul_f32 v[106:107], v[90:91], v[106:107]
    v_exp_f32 v61, v61
    v_pk_mul_f32 v[108:109], v[92:93], v[108:109]
    v_exp_f32 v62, v62
    v_pk_mul_f32 v[110:111], v[94:95], v[110:111]
    v_exp_f32 v63, v63
    v_cvt_pk_bf16_f32 v96, v96, v97
    v_exp_f32 v32, v32
    s_waitcnt lgkmcnt(1)
    v_smfmac_f32_32x32x32_bf16 v[64:79], v[28:31], v[56:63], v0
    s_mov_b64 exec, s[64:65]
    ds_read_b128 v[24:27], v2 offset:2048
    ds_read_b128 v[28:31], v2 offset:2304
    s_mov_b64 exec, -1
    v_cvt_pk_bf16_f32 v97, v98, v99
    v_exp_f32 v33, v33
    v_cvt_pk_bf16_f32 v98, v100, v101
    v_exp_f32 v34, v34
    v_cvt_pk_bf16_f32 v99, v102, v103
    v_exp_f32 v35, v35
    v_cvt_pk_bf16_f32 v100, v104, v105
    v_exp_f32 v36, v36
    s_waitcnt lgkmcnt(2)
    v_mfma_f32_32x32x16_bf16 v[48:63], v[20:23], v[16:19], 0
    ds_read_b128 v[20:23], v1 offset:6144
    v_cvt_pk_bf16_f32 v101, v106, v107
    v_exp_f32 v37, v37
    v_cvt_pk_bf16_f32 v102, v108, v109
    v_exp_f32 v38, v38
    v_cvt_pk_bf16_f32 v103, v110, v111
    v_exp_f32 v39, v39
    v_exp_f32 v40, v40
    v_exp_f32 v41, v41
    v_exp_f32 v42, v42
    s_waitcnt lgkmcnt(2)
    v_smfmac_f32_32x32x32_bf16 v[64:79], v[24:27], v[32:39], v0
    v_exp_f32 v43, v43
    v_exp_f32 v44, v44
    v_exp_f32 v45, v45
    v_exp_f32 v46, v46
    v_exp_f32 v47, v47
    v_exp_f32 v48, v48
    s_add_u32 m0, s58, 4096
    s_waitcnt lgkmcnt(1)
    v_smfmac_f32_32x32x32_bf16 v[64:79], v[28:31], v[40:47], v0
    s_mov_b64 exec, s[64:65]
    ds_read_b128 v[24:27], v2 offset:4096
    ds_read_b128 v[28:31], v2 offset:4352
    s_mov_b64 exec, -1
    s_add_u32 s81, s77, 113664
    buffer_load_dwordx4 v125, s[16:19], s81 offen offset:1024 lds
    v_exp_f32 v49, v49
    v_exp_f32 v50, v50
    v_exp_f32 v51, v51
    v_exp_f32 v52, v52
    s_waitcnt lgkmcnt(2)
    v_mfma_f32_32x32x16_bf16 v[32:47], v[20:23], v[16:19], 0
    ds_read_b128 v[20:23], v1 offset:8192
    v_exp_f32 v53, v53
    v_exp_f32 v54, v54
    v_exp_f32 v55, v55
    v_exp_f32 v56, v56
    v_exp_f32 v57, v57
    v_exp_f32 v58, v58
    s_waitcnt lgkmcnt(2)
    v_smfmac_f32_32x32x32_bf16 v[64:79], v[24:27], v[48:55], v0
    s_waitcnt vmcnt(1)
    ds_write_b32 v8, v8 offset:0
    v_exp_f32 v59, v59
    v_exp_f32 v60, v60
    v_exp_f32 v61, v61
    v_exp_f32 v62, v62
    v_exp_f32 v63, v63
    s_setprio 2
    v_exp_f32 v32, v32
    s_waitcnt lgkmcnt(2)
    v_smfmac_f32_32x32x32_bf16 v[64:79], v[28:31], v[56:63], v0
    s_mov_b64 exec, s[64:65]
    ds_read_b128 v[24:27], v2 offset:6144
    ds_read_b128 v[28:31], v2 offset:6400
    s_mov_b64 exec, -1
    v_exp_f32 v33, v33
    v_exp_f32 v34, v34
    v_exp_f32 v35, v35
    v_exp_f32 v36, v36
    s_waitcnt lgkmcnt(2)
    v_mfma_f32_32x32x16_bf16 v[48:63], v[20:23], v[16:19], 0
    ds_read_b128 v[20:23], v1 offset:10240
    v_exp_f32 v37, v37
    v_exp_f32 v38, v38
    v_exp_f32 v39, v39
    v_exp_f32 v40, v40
    v_exp_f32 v41, v41
    v_exp_f32 v42, v42
    s_add_u32 m0, s58, 6144
    s_waitcnt lgkmcnt(2)
    v_smfmac_f32_32x32x32_bf16 v[64:79], v[24:27], v[32:39], v0
    buffer_load_dwordx4 v125, s[20:23], s77 offen lds
    v_exp_f32 v43, v43
    v_exp_f32 v44, v44
    v_exp_f32 v45, v45
    v_exp_f32 v46, v46
    v_exp_f32 v47, v47
    v_exp_f32 v48, v48
    s_waitcnt lgkmcnt(1)
    v_smfmac_f32_32x32x32_bf16 v[64:79], v[28:31], v[40:47], v0
    s_mov_b64 exec, s[64:65]
    ds_read_b128 v[24:27], v2 offset:8192
    ds_read_b128 v[28:31], v2 offset:8448
    s_mov_b64 exec, -1
    v_exp_f32 v49, v49
    v_exp_f32 v50, v50
    v_exp_f32 v51, v51
    v_exp_f32 v52, v52
    s_waitcnt lgkmcnt(2)
    v_mfma_f32_32x32x16_bf16 v[32:47], v[20:23], v[16:19], 0
    ds_read_b128 v[20:23], v1 offset:12288
    v_exp_f32 v53, v53
    v_exp_f32 v54, v54
    v_exp_f32 v55, v55
    v_exp_f32 v56, v56
    v_exp_f32 v57, v57
    v_exp_f32 v58, v58
    s_waitcnt lgkmcnt(2)
    v_smfmac_f32_32x32x32_bf16 v[64:79], v[24:27], v[48:55], v0
    v_exp_f32 v59, v59
    v_exp_f32 v60, v60
    v_exp_f32 v61, v61
    v_exp_f32 v62, v62
    v_exp_f32 v63, v63
    v_exp_f32 v32, v32
    s_waitcnt lgkmcnt(1)
    v_smfmac_f32_32x32x32_bf16 v[64:79], v[28:31], v[56:63], v0
    s_mov_b64 exec, s[64:65]
    ds_read_b128 v[24:27], v2 offset:10240
    ds_read_b128 v[28:31], v2 offset:10496
    s_mov_b64 exec, -1
    v_exp_f32 v33, v33
    v_exp_f32 v34, v34
    v_exp_f32 v35, v35
    v_exp_f32 v36, v36
    s_waitcnt lgkmcnt(2)
    v_mfma_f32_32x32x16_bf16 v[48:63], v[20:23], v[16:19], 0
    ds_read_b128 v[20:23], v1 offset:14336
    ds_read_b32 v10, v9 offset:0
    v_exp_f32 v37, v37
    v_exp_f32 v38, v38
    v_exp_f32 v39, v39
    v_exp_f32 v40, v40
    v_exp_f32 v41, v41
    v_exp_f32 v42, v42
    s_waitcnt lgkmcnt(2)
    v_smfmac_f32_32x32x32_bf16 v[64:79], v[24:27], v[32:39], v0
    s_add_u32 s81, s77, 113664
    buffer_load_dwordx4 v125, s[20:23], s81 offen offset:1024 lds
    v_exp_f32 v43, v43
    v_exp_f32 v44, v44
    v_exp_f32 v45, v45
    v_exp_f32 v46, v46
    v_exp_f32 v47, v47
    s_setprio 1
    v_exp_f32 v48, v48
    v_smfmac_f32_32x32x32_bf16 v[64:79], v[28:31], v[40:47], v0
    s_mov_b64 exec, s[64:65]
    ds_read_b128 v[24:27], v2 offset:12288
    ds_read_b128 v[28:31], v2 offset:12544
    s_mov_b64 exec, -1
    s_waitcnt lgkmcnt(2)
    v_cmp_eq_u32 vcc, 0, v10
    s_cbranch_vccnz L_ep_s_30
L_ep_b_29:
    v_exp_f32 v49, v49
    v_exp_f32 v50, v50
    v_exp_f32 v51, v51
    v_exp_f32 v52, v52
    v_mfma_f32_32x32x16_bf16 v[32:47], v[20:23], v[16:19], 0
    ds_read_b128 v[20:23], v1 offset:16384
    v_exp_f32 v53, v53
    v_exp_f32 v54, v54
    v_exp_f32 v55, v55
    v_exp_f32 v56, v56
    v_exp_f32 v57, v57
    v_exp_f32 v58, v58
    s_waitcnt lgkmcnt(2)
    v_smfmac_f32_32x32x32_bf16 v[64:79], v[24:27], v[48:55], v0
    v_exp_f32 v59, v59
    v_exp_f32 v60, v60
    v_exp_f32 v61, v61
    v_exp_f32 v62, v62
    v_exp_f32 v63, v63
    s_setprio 0
    v_exp_f32 v32, v32
    s_waitcnt lgkmcnt(1)
    v_smfmac_f32_32x32x32_bf16 v[64:79], v[28:31], v[56:63], v0
    s_mov_b64 exec, s[64:65]
    ds_read_b128 v[24:27], v2 offset:14336
    ds_read_b128 v[28:31], v2 offset:14592
    s_mov_b64 exec, -1
    v_mov_b32 v11, 0
    s_mov_b64 exec, 0xff
    buffer_atomic_or v11, v13, s[40:43], s72 offen offset:0 sc0 sc1
    s_mov_b64 exec, -1
    v_exp_f32 v33, v33
    v_exp_f32 v34, v34
    v_exp_f32 v35, v35
    v_exp_f32 v36, v36
    s_waitcnt lgkmcnt(2)
    v_mfma_f32_32x32x16_bf16 v[48:63], v[20:23], v[16:19], 0
    ds_read_b128 v[20:23], v1 offset:18432
    s_waitcnt vmcnt(1)
    ds_write_b32 v8, v8 offset:32
    v_exp_f32 v37, v37
    v_exp_f32 v38, v38
    v_exp_f32 v39, v39
    v_exp_f32 v40, v40
    v_exp_f32 v41, v41
    v_exp_f32 v42, v42
    s_waitcnt lgkmcnt(2)
    v_smfmac_f32_32x32x32_bf16 v[64:79], v[24:27], v[32:39], v0
    v_exp_f32 v43, v43
    v_exp_f32 v44, v44
    v_exp_f32 v45, v45
    v_exp_f32 v46, v46
    v_exp_f32 v47, v47
    s_setprio 3
    v_exp_f32 v48, v48
    v_smfmac_f32_32x32x32_bf16 v[64:79], v[28:31], v[40:47], v0
    s_mov_b64 exec, s[64:65]
    ds_read_b128 v[24:27], v2 offset:16384
    ds_read_b128 v[28:31], v2 offset:16640
    s_mov_b64 exec, -1
    v_exp_f32 v49, v49
    v_exp_f32 v50, v50
    v_exp_f32 v51, v51
    v_exp_f32 v52, v52
    s_waitcnt lgkmcnt(2)
    v_mfma_f32_32x32x16_bf16 v[32:47], v[20:23], v[16:19], 0
    ds_read_b128 v[20:23], v1 offset:20480
    v_exp_f32 v53, v53
    v_exp_f32 v54, v54
    v_exp_f32 v55, v55
    v_exp_f32 v56, v56
    v_exp_f32 v57, v57
    v_exp_f32 v58, v58
    s_waitcnt lgkmcnt(2)
    v_smfmac_f32_32x32x32_bf16 v[64:79], v[24:27], v[48:55], v0
    ds_read_b32 v10, v9 offset:32
    v_exp_f32 v59, v59
    v_exp_f32 v60, v60
    v_exp_f32 v61, v61
    v_exp_f32 v62, v62
    v_exp_f32 v63, v63
    v_exp_f32 v32, v32
    v_exp_f32 v33, v33
    s_waitcnt lgkmcnt(2)
    v_smfmac_f32_32x32x32_bf16 v[64:79], v[28:31], v[56:63], v0
    s_mov_b64 exec, s[64:65]
    ds_read_b128 v[24:27], v2 offset:18432
    ds_read_b128 v[28:31], v2 offset:18688
    s_mov_b64 exec, -1
    s_waitcnt lgkmcnt(2)
    v_cmp_eq_u32 vcc, 0, v10
    s_cbranch_vccnz L_ep_s_32
L_ep_b_31:
    ds_read_b64_tr_b16 v[116:117], v14 offset:4096
    ds_read_b64_tr_b16 v[118:119], v14 offset:4224
    ds_read_b64_tr_b16 v[120:121], v14 offset:4608
    ds_read_b64_tr_b16 v[122:123], v14 offset:4736
    ds_read_b64_tr_b16 v[112:113], v14 offset:5120
    ds_read_b64_tr_b16 v[114:115], v14 offset:5248
    v_exp_f32 v34, v34
    v_exp_f32 v35, v35
    v_exp_f32 v36, v36
    v_mfma_f32_32x32x16_bf16 v[48:63], v[20:23], v[16:19], 0
    ds_read_b128 v[20:23], v1 offset:22528
    s_waitcnt vmcnt(0)
    v_cmp_gt_u32 vcc, 0x80, v11
    s_nop 0
    s_and_b32 s3, vcc_lo, 0xff
    s_cbranch_scc1 L_kp2_s_34
L_kp2_b_33:
    s_add_u32 m0, s62, 32768
    s_add_u32 s82, s54, 2
    s_and_b32 s82, s82, 7
    s_lshl_b32 s82, s82, 14
    s_add_u32 s69, s82, s70
    buffer_load_dwordx4 v1, s[40:43], s69 offen sc1 lds
    v_exp_f32 v37, v37
    v_exp_f32 v38, v38
    v_exp_f32 v39, v39
    v_exp_f32 v40, v40
    v_exp_f32 v41, v41
    s_waitcnt lgkmcnt(2)
    v_smfmac_f32_32x32x32_bf16 v[64:79], v[24:27], v[32:39], v0
    buffer_load_dwordx4 v1, s[40:43], s69 offen offset:1024 sc1 lds
    v_exp_f32 v42, v42
    v_exp_f32 v43, v43
    v_exp_f32 v44, v44
    v_exp_f32 v45, v45
    v_mfma_f32_32x32x16_bf16 v[80:95], v[116:119], v[128:131], 0
    ds_read_b64_tr_b16 v[116:117], v14 offset:5632
    ds_read_b64_tr_b16 v[118:119], v14 offset:5760
    v_lshlrev_b32 v13, 8, v1
    v_xor_b32 v5, 64, v3
    s_lshr_b32 s3, s52, 1
    s_lshl_b32 s3, s3, 10
    s_lshl_b32 s72, s56, 13
    s_add_u32 s72, s72, s3
    v_exp_f32 v46, v46
    v_exp_f32 v47, v47
    v_exp_f32 v48, v48
    v_exp_f32 v49, v49
    v_smfmac_f32_32x32x32_bf16 v[64:79], v[28:31], v[40:47], v0
    s_mov_b64 exec, s[64:65]
    ds_read_b128 v[24:27], v2 offset:20480
    ds_read_b128 v[28:31], v2 offset:20736
    s_mov_b64 exec, -1
    v_exp_f32 v50, v50
    v_exp_f32 v51, v51
    v_exp_f32 v52, v52
    s_waitcnt lgkmcnt(2)
    v_mfma_f32_32x32x16_bf16 v[32:47], v[20:23], v[16:19], 0
    ds_read_b128 v[20:23], v1 offset:24576
    buffer_store_dwordx4 v[96:99], v1, s[40:43], s61 offen sc1
    v_exp_f32 v53, v53
    v_exp_f32 v54, v54
    v_exp_f32 v55, v55
    v_mfma_f32_32x32x16_bf16 v[80:95], v[120:123], v[132:135], v[80:95]
    ds_read_b64_tr_b16 v[120:121], v14 offset:16384
    ds_read_b64_tr_b16 v[122:123], v14 offset:16512
    v_exp_f32 v56, v56
    v_exp_f32 v57, v57
    v_exp_f32 v58, v58
    v_exp_f32 v59, v59
    s_waitcnt lgkmcnt(2)
    v_smfmac_f32_32x32x32_bf16 v[64:79], v[24:27], v[48:55], v0
    s_waitcnt vmcnt(1)
    ds_write_b32 v8, v8 offset:64
    v_exp_f32 v60, v60
    v_exp_f32 v61, v61
    v_exp_f32 v62, v62
    v_mfma_f32_32x32x16_bf16 v[80:95], v[112:115], v[136:139], v[80:95]
    ds_read_b64_tr_b16 v[112:113], v14 offset:16896
    ds_read_b64_tr_b16 v[114:115], v14 offset:17024
    v_exp_f32 v63, v63
    s_setprio 2
    v_exp_f32 v32, v32
    v_exp_f32 v33, v33
    v_smfmac_f32_32x32x32_bf16 v[64:79], v[28:31], v[56:63], v0
    s_mov_b64 exec, s[64:65]
    ds_read_b128 v[24:27], v2 offset:22528
    ds_read_b128 v[28:31], v2 offset:22784
    s_mov_b64 exec, -1
    v_exp_f32 v34, v34
    v_exp_f32 v35, v35
    v_exp_f32 v36, v36
    v_mfma_f32_32x32x16_bf16 v[48:63], v[20:23], v[16:19], 0
    ds_read_b128 v[20:23], v1 offset:26624
    v_exp_f32 v37, v37
    v_exp_f32 v38, v38
    v_exp_f32 v39, v39
    v_mfma_f32_32x32x16_bf16 v[80:95], v[116:119], v[140:143], v[80:95]
    ds_read_b64_tr_b16 v[116:117], v14 offset:17408
    ds_read_b64_tr_b16 v[118:119], v14 offset:17536
    v_exp_f32 v40, v40
    v_exp_f32 v41, v41
    v_exp_f32 v42, v42
    v_exp_f32 v43, v43
    s_waitcnt lgkmcnt(2)
    v_smfmac_f32_32x32x32_bf16 v[64:79], v[24:27], v[32:39], v0
    v_exp_f32 v44, v44
    v_exp_f32 v45, v45
    v_exp_f32 v46, v46
    v_mfma_f32_32x32x16_bf16 v[80:95], v[120:123], v[144:147], v[80:95]
    ds_read_b64_tr_b16 v[120:121], v14 offset:17920
    ds_read_b64_tr_b16 v[122:123], v14 offset:18048
    v_exp_f32 v47, v47
    v_exp_f32 v48, v48
    v_exp_f32 v49, v49
    v_smfmac_f32_32x32x32_bf16 v[64:79], v[28:31], v[40:47], v0
    s_mov_b64 exec, s[64:65]
    ds_read_b128 v[24:27], v2 offset:24576
    ds_read_b128 v[28:31], v2 offset:24832
    s_mov_b64 exec, -1
    v_exp_f32 v50, v50
    v_exp_f32 v51, v51
    v_exp_f32 v52, v52
    v_mfma_f32_32x32x16_bf16 v[32:47], v[20:23], v[16:19], 0
    ds_read_b128 v[20:23], v1 offset:28672
    ds_read_b32 v10, v9 offset:64
    v_exp_f32 v53, v53
    v_exp_f32 v54, v54
    v_exp_f32 v55, v55
    v_exp_f32 v56, v56
    v_exp_f32 v57, v57
    s_waitcnt lgkmcnt(2)
    v_smfmac_f32_32x32x32_bf16 v[64:79], v[24:27], v[48:55], v0
    s_waitcnt lgkmcnt(0)
    v_cmp_eq_u32 vcc, 0, v10
    s_cbranch_vccnz L_ep_s_36
L_ep_b_35:
    v_exp_f32 v58, v58
    v_exp_f32 v59, v59
    v_exp_f32 v60, v60
    v_exp_f32 v61, v61
    v_mfma_f32_32x32x16_bf16 v[80:95], v[112:115], v[148:151], v[80:95]
    ds_read_b64_tr_b16 v[112:113], v14 offset:28672
    ds_read_b64_tr_b16 v[114:115], v14 offset:28800
    s_mov_b32 m0, s62
    s_add_u32 s82, s54, 3
    s_and_b32 s82, s82, 7
    s_lshl_b32 s82, s82, 14
    s_add_u32 s69, s82, s70
    buffer_load_dwordx4 v1, s[40:43], s69 offen sc1 lds
    v_exp_f32 v62, v62
    v_exp_f32 v63, v63
    v_exp_f32 v32, v32
    v_exp_f32 v33, v33
    v_smfmac_f32_32x32x32_bf16 v[64:79], v[28:31], v[56:63], v0
    s_mov_b64 exec, s[64:65]
    ds_read_b128 v[24:27], v2 offset:26624
    ds_read_b128 v[28:31], v2 offset:26880
    s_mov_b64 exec, -1
    buffer_load_dwordx4 v1, s[40:43], s69 offen offset:1024 sc1 lds
    v_exp_f32 v34, v34
    v_exp_f32 v35, v35
    v_exp_f32 v36, v36
    v_mfma_f32_32x32x16_bf16 v[48:63], v[20:23], v[16:19], 0
    ds_read_b128 v[20:23], v1 offset:30720
    v_exp_f32 v37, v37
    v_exp_f32 v38, v38
    v_exp_f32 v39, v39
    v_mfma_f32_32x32x16_bf16 v[80:95], v[116:119], v[152:155], v[80:95]
    ds_read_b64_tr_b16 v[116:117], v14 offset:29184
    ds_read_b64_tr_b16 v[118:119], v14 offset:29312
    v_exp_f32 v40, v40
    v_exp_f32 v41, v41
    v_exp_f32 v42, v42
    v_exp_f32 v43, v43
    s_waitcnt lgkmcnt(2)
    v_smfmac_f32_32x32x32_bf16 v[64:79], v[24:27], v[32:39], v0
    buffer_store_dwordx4 v[100:103], v1, s[40:43], s68 offen sc1
    v_exp_f32 v44, v44
    v_exp_f32 v45, v45
    v_exp_f32 v46, v46
    v_mfma_f32_32x32x16_bf16 v[80:95], v[120:123], v[156:159], v[80:95]
    ds_read_b64_tr_b16 v[120:121], v14 offset:29696
    ds_read_b64_tr_b16 v[122:123], v14 offset:29824
    v_exp_f32 v47, v47
    s_setprio 1
    v_exp_f32 v48, v48
    v_exp_f32 v49, v49
    v_smfmac_f32_32x32x32_bf16 v[64:79], v[28:31], v[40:47], v0
    s_mov_b64 exec, s[64:65]
    ds_read_b128 v[24:27], v2 offset:28672
    ds_read_b128 v[28:31], v2 offset:28928
    s_mov_b64 exec, -1
    v_exp_f32 v50, v50
    v_exp_f32 v51, v51
    v_exp_f32 v52, v52
    v_mfma_f32_32x32x16_bf16 v[32:47], v[20:23], v[16:19], 0
    ds_read_b128 v[20:23], v1 offset:32768
    v_exp_f32 v53, v53
    v_exp_f32 v54, v54
    v_exp_f32 v55, v55
    v_mfma_f32_32x32x16_bf16 v[80:95], v[112:115], v[160:163], v[80:95]
    ds_read_b64_tr_b16 v[112:113], v14 offset:30208
    ds_read_b64_tr_b16 v[114:115], v14 offset:30336
    v_exp_f32 v56, v56
    v_exp_f32 v57, v57
    v_exp_f32 v58, v58
    v_exp_f32 v59, v59
    s_waitcnt lgkmcnt(2)
    v_smfmac_f32_32x32x32_bf16 v[64:79], v[24:27], v[48:55], v0
    v_exp_f32 v60, v60
    v_exp_f32 v61, v61
    v_exp_f32 v62, v62
    v_mfma_f32_32x32x16_bf16 v[80:95], v[116:119], v[164:167], v[80:95]
    ds_read_b64_tr_b16 v[116:117], v14 offset:40960
    ds_read_b64_tr_b16 v[118:119], v14 offset:41088
    v_exp_f32 v63, v63
    s_setprio 0
    v_exp_f32 v32, v32
    v_exp_f32 v33, v33
    v_smfmac_f32_32x32x32_bf16 v[64:79], v[28:31], v[56:63], v0
    s_mov_b64 exec, s[64:65]
    ds_read_b128 v[24:27], v2 offset:30720
    ds_read_b128 v[28:31], v2 offset:30976
    s_mov_b64 exec, -1
    v_exp_f32 v34, v34
    v_exp_f32 v35, v35
    v_exp_f32 v36, v36
    v_mfma_f32_32x32x16_bf16 v[48:63], v[20:23], v[16:19], 0
    ds_read_b128 v[20:23], v1 offset:34816
    v_exp_f32 v37, v37
    v_exp_f32 v38, v38
    v_exp_f32 v39, v39
    v_exp_f32 v40, v40
    v_exp_f32 v41, v41
    s_waitcnt lgkmcnt(2)
    v_smfmac_f32_32x32x32_bf16 v[64:79], v[24:27], v[32:39], v0
    v_exp_f32 v42, v42
    v_exp_f32 v43, v43
    v_exp_f32 v44, v44
    v_exp_f32 v45, v45
    v_mfma_f32_32x32x16_bf16 v[80:95], v[120:123], v[168:171], v[80:95]
    ds_read_b64_tr_b16 v[120:121], v14 offset:41472
    ds_read_b64_tr_b16 v[122:123], v14 offset:41600
    v_exp_f32 v46, v46
    v_exp_f32 v47, v47
    s_setprio 3
    v_exp_f32 v48, v48
    v_exp_f32 v49, v49
    s_waitcnt lgkmcnt(2)
    v_smfmac_f32_32x32x32_bf16 v[64:79], v[28:31], v[40:47], v0
    s_mov_b64 exec, s[64:65]
    ds_read_b128 v[24:27], v2 offset:32768
    ds_read_b128 v[28:31], v2 offset:33024
    s_mov_b64 exec, -1
    v_exp_f32 v50, v50
    v_exp_f32 v51, v51
    v_exp_f32 v52, v52
    v_mfma_f32_32x32x16_bf16 v[32:47], v[20:23], v[16:19], 0
    ds_read_b128 v[20:23], v1 offset:36864
    v_lshlrev_b32 v10, 3, v1
    s_lshl3_add_u32 s3, s2, s52
    s_mul_i32 s3, s3, 896
    s_add_u32 m0, s62, 50176
    s_mov_b64 exec, 127
    buffer_load_dword v10, s[24:27], s3 offen lds
    s_mov_b64 exec, -1
    v_exp_f32 v53, v53
    v_exp_f32 v54, v54
    v_exp_f32 v55, v55
    v_mfma_f32_32x32x16_bf16 v[80:95], v[112:115], v[172:175], v[80:95]
    ds_read_b64_tr_b16 v[112:113], v14 offset:41984
    ds_read_b64_tr_b16 v[114:115], v14 offset:42112
    v_lshlrev_b32 v10, 3, v1
    s_lshl3_add_u32 s3, s2, s52
    s_mul_i32 s3, s3, 256
    s_mov_b64 exec, 3
    buffer_load_dword v10, s[12:15], s3 offen lds
    s_mov_b64 exec, -1
    v_exp_f32 v56, v56
    v_exp_f32 v57, v57
    v_exp_f32 v58, v58
    v_exp_f32 v59, v59
    s_waitcnt lgkmcnt(2)
    v_smfmac_f32_32x32x32_bf16 v[64:79], v[24:27], v[48:55], v0
    v_exp_f32 v60, v60
    v_exp_f32 v61, v61
    v_exp_f32 v62, v62
    v_mfma_f32_32x32x16_bf16 v[80:95], v[116:119], v[176:179], v[80:95]
    ds_read_b64_tr_b16 v[116:117], v14 offset:42496
    ds_read_b64_tr_b16 v[118:119], v14 offset:42624
    v_exp_f32 v63, v63
    v_exp_f32 v32, v32
    v_exp_f32 v33, v33
    v_smfmac_f32_32x32x32_bf16 v[64:79], v[28:31], v[56:63], v0
    s_mov_b64 exec, s[64:65]
    ds_read_b128 v[24:27], v2 offset:34816
    ds_read_b128 v[28:31], v2 offset:35072
    s_mov_b64 exec, -1
    s_waitcnt vmcnt(2)
    s_mov_b64 exec, 2
    buffer_atomic_add v1, off, s[40:43], s71 offset:4 sc1
    s_mov_b64 exec, -1
    v_exp_f32 v34, v34
    v_exp_f32 v35, v35
    v_exp_f32 v36, v36
    v_mfma_f32_32x32x16_bf16 v[48:63], v[20:23], v[16:19], 0
    ds_read_b128 v[20:23], v1 offset:38912
    v_exp_f32 v37, v37
    v_exp_f32 v38, v38
    v_exp_f32 v39, v39
    v_mfma_f32_32x32x16_bf16 v[80:95], v[120:123], v[180:183], v[80:95]
    ds_read_b64_tr_b16 v[120:121], v15 offset:4096
    ds_read_b64_tr_b16 v[122:123], v15 offset:4224
    v_exp_f32 v40, v40
    v_exp_f32 v41, v41
    v_exp_f32 v42, v42
    v_exp_f32 v43, v43
    s_waitcnt lgkmcnt(2)
    v_smfmac_f32_32x32x32_bf16 v[64:79], v[24:27], v[32:39], v0
    v_exp_f32 v44, v44
    v_exp_f32 v45, v45
    v_exp_f32 v46, v46
    v_mfma_f32_32x32x16_bf16 v[80:95], v[112:115], v[184:187], v[80:95]
    ds_read_b64_tr_b16 v[112:113], v15 offset:4608
    ds_read_b64_tr_b16 v[114:115], v15 offset:4736
    v_exp_f32 v47, v47
    v_exp_f32 v48, v48
    v_exp_f32 v49, v49
    v_smfmac_f32_32x32x32_bf16 v[64:79], v[28:31], v[40:47], v0
    s_mov_b64 exec, s[64:65]
    ds_read_b128 v[24:27], v2 offset:36864
    ds_read_b128 v[28:31], v2 offset:37120
    s_mov_b64 exec, -1
    ds_write_b32 v8, v8 offset:96
    v_exp_f32 v50, v50
    v_exp_f32 v51, v51
    v_exp_f32 v52, v52
    v_mfma_f32_32x32x16_bf16 v[32:47], v[20:23], v[16:19], 0
    ds_read_b128 v[20:23], v1 offset:40960
    v_exp_f32 v53, v53
    v_exp_f32 v54, v54
    v_exp_f32 v55, v55
    v_exp_f32 v56, v56
    v_exp_f32 v57, v57
    s_waitcnt lgkmcnt(2)
    v_smfmac_f32_32x32x32_bf16 v[64:79], v[24:27], v[48:55], v0
    v_exp_f32 v58, v58
    v_exp_f32 v59, v59
    v_exp_f32 v60, v60
    v_exp_f32 v61, v61
    v_mfma_f32_32x32x16_bf16 v[80:95], v[116:119], v[188:191], v[80:95]
    ds_read_b64_tr_b16 v[116:117], v15 offset:5120
    ds_read_b64_tr_b16 v[118:119], v15 offset:5248
    v_exp_f32 v62, v62
    v_exp_f32 v63, v63
    s_setprio 2
    v_exp_f32 v32, v32
    v_exp_f32 v33, v33
    s_add_u32 m0, s58, 8192
    v_smfmac_f32_32x32x32_bf16 v[64:79], v[28:31], v[56:63], v0
    s_mov_b64 exec, s[64:65]
    ds_read_b128 v[24:27], v2 offset:38912
    ds_read_b128 v[28:31], v2 offset:39168
    s_mov_b64 exec, -1
    buffer_load_dwordx4 v12, s[24:27], s75 offen lds
    v_exp_f32 v34, v34
    v_exp_f32 v35, v35
    v_exp_f32 v36, v36
    s_waitcnt lgkmcnt(2)
    v_mfma_f32_32x32x16_bf16 v[48:63], v[20:23], v[16:19], 0
    ds_read_b128 v[20:23], v1 offset:43008
    v_exp_f32 v37, v37
    v_exp_f32 v38, v38
    v_exp_f32 v39, v39
    v_mfma_f32_32x32x16_bf16 v[80:95], v[120:123], v[192:195], v[80:95]
    ds_read_b64_tr_b16 v[120:121], v15 offset:5632
    ds_read_b64_tr_b16 v[122:123], v15 offset:5760
    buffer_load_dwordx4 v124, s[24:27], s75 offen offset:1024 lds
    s_add_u32 s75, s75, 32768
    v_exp_f32 v40, v40
    v_exp_f32 v41, v41
    v_exp_f32 v42, v42
    v_exp_f32 v43, v43
    s_waitcnt lgkmcnt(2)
    v_smfmac_f32_32x32x32_bf16 v[64:79], v[24:27], v[32:39], v0
    v_exp_f32 v44, v44
    v_exp_f32 v45, v45
    v_exp_f32 v46, v46
    v_mfma_f32_32x32x16_bf16 v[80:95], v[112:115], v[196:199], v[80:95]
    ds_read_b64_tr_b16 v[112:113], v15 offset:16384
    ds_read_b64_tr_b16 v[114:115], v15 offset:16512
    v_exp_f32 v47, v47
    v_exp_f32 v48, v48
    v_exp_f32 v49, v49
    v_smfmac_f32_32x32x32_bf16 v[64:79], v[28:31], v[40:47], v0
    s_mov_b64 exec, s[64:65]
    ds_read_b128 v[24:27], v2 offset:40960
    ds_read_b128 v[28:31], v2 offset:41216
    s_mov_b64 exec, -1
    v_exp_f32 v50, v50
    v_exp_f32 v51, v51
    v_exp_f32 v52, v52
    v_mfma_f32_32x32x16_bf16 v[32:47], v[20:23], v[16:19], 0
    ds_read_b128 v[20:23], v1 offset:45056
    v_exp_f32 v53, v53
    v_exp_f32 v54, v54
    v_exp_f32 v55, v55
    v_mfma_f32_32x32x16_bf16 v[80:95], v[116:119], v[200:203], v[80:95]
    ds_read_b64_tr_b16 v[116:117], v15 offset:16896
    ds_read_b64_tr_b16 v[118:119], v15 offset:17024
    v_exp_f32 v56, v56
    v_exp_f32 v57, v57
    v_exp_f32 v58, v58
    v_exp_f32 v59, v59
    s_waitcnt lgkmcnt(2)
    v_smfmac_f32_32x32x32_bf16 v[64:79], v[24:27], v[48:55], v0
    ds_read_b32 v10, v9 offset:96
    v_exp_f32 v60, v60
    v_exp_f32 v61, v61
    v_exp_f32 v62, v62
    v_mfma_f32_32x32x16_bf16 v[80:95], v[120:123], v[204:207], v[80:95]
    ds_read_b64_tr_b16 v[120:121], v15 offset:17408
    ds_read_b64_tr_b16 v[122:123], v15 offset:17536
    v_exp_f32 v63, v63
    v_exp_f32 v32, v32
    v_exp_f32 v33, v33
    v_smfmac_f32_32x32x32_bf16 v[64:79], v[28:31], v[56:63], v0
    s_mov_b64 exec, s[64:65]
    ds_read_b128 v[24:27], v2 offset:43008
    ds_read_b128 v[28:31], v2 offset:43264
    s_mov_b64 exec, -1
    s_waitcnt lgkmcnt(2)
    v_cmp_eq_u32 vcc, 0, v10
    s_cbranch_vccnz L_ep_s_38
L_ep_b_37:
    v_exp_f32 v34, v34
    v_exp_f32 v35, v35
    v_exp_f32 v36, v36
    v_mfma_f32_32x32x16_bf16 v[48:63], v[20:23], v[16:19], 0
    ds_read_b128 v[20:23], v1 offset:47104
    s_add_u32 m0, s62, 16384
    s_add_u32 s82, s54, 4
    s_and_b32 s82, s82, 7
    s_lshl_b32 s82, s82, 14
    s_add_u32 s69, s82, s70
    buffer_load_dwordx4 v1, s[40:43], s69 offen sc1 lds
    v_exp_f32 v37, v37
    v_exp_f32 v38, v38
    v_exp_f32 v39, v39
    v_exp_f32 v40, v40
    v_exp_f32 v41, v41
    s_waitcnt lgkmcnt(2)
    v_smfmac_f32_32x32x32_bf16 v[64:79], v[24:27], v[32:39], v0
    buffer_load_dwordx4 v1, s[40:43], s69 offen offset:1024 sc1 lds
    v_exp_f32 v42, v42
    v_exp_f32 v43, v43
    v_exp_f32 v44, v44
    v_exp_f32 v45, v45
    v_mfma_f32_32x32x16_bf16 v[80:95], v[112:115], v[208:211], v[80:95]
    ds_read_b64_tr_b16 v[112:113], v15 offset:17920
    ds_read_b64_tr_b16 v[114:115], v15 offset:18048
    v_exp_f32 v46, v46
    v_exp_f32 v47, v47
    s_setprio 1
    v_exp_f32 v48, v48
    v_exp_f32 v49, v49
    s_add_u32 m0, s58, 10240
    s_waitcnt lgkmcnt(2)
    v_smfmac_f32_32x32x32_bf16 v[64:79], v[28:31], v[40:47], v0
    s_mov_b64 exec, s[64:65]
    ds_read_b128 v[24:27], v2 offset:45056
    ds_read_b128 v[28:31], v2 offset:45312
    s_mov_b64 exec, -1
    buffer_load_dwordx4 v12, s[24:27], s75 offen lds
    v_exp_f32 v50, v50
    v_exp_f32 v51, v51
    v_exp_f32 v52, v52
    v_mfma_f32_32x32x16_bf16 v[32:47], v[20:23], v[16:19], 0
    ds_read_b128 v[20:23], v1 offset:0
    v_exp_f32 v53, v53
    v_exp_f32 v54, v54
    v_exp_f32 v55, v55
    v_mfma_f32_32x32x16_bf16 v[80:95], v[116:119], v[212:215], v[80:95]
    ds_read_b64_tr_b16 v[116:117], v15 offset:28672
    ds_read_b64_tr_b16 v[118:119], v15 offset:28800
    buffer_load_dwordx4 v124, s[24:27], s75 offen offset:1024 lds
    s_add_u32 s75, s75, 32768
    v_exp_f32 v56, v56
    v_exp_f32 v57, v57
    v_exp_f32 v58, v58
    v_exp_f32 v59, v59
    s_waitcnt lgkmcnt(2)
    v_smfmac_f32_32x32x32_bf16 v[64:79], v[24:27], v[48:55], v0
    v_mov_b32 v11, 0
    s_mov_b64 exec, 0x3
    buffer_atomic_or v11, v13, s[40:43], s72 offen offset:4 sc0 sc1
    s_mov_b64 exec, -1
    v_exp_f32 v60, v60
    v_exp_f32 v61, v61
    v_exp_f32 v62, v62
    v_mfma_f32_32x32x16_bf16 v[80:95], v[120:123], v[216:219], v[80:95]
    ds_read_b64_tr_b16 v[120:121], v15 offset:29184
    ds_read_b64_tr_b16 v[122:123], v15 offset:29312
    v_exp_f32 v63, v63
    s_setprio 0
    v_exp_f32 v32, v32
    v_exp_f32 v33, v33
    v_smfmac_f32_32x32x32_bf16 v[64:79], v[28:31], v[56:63], v0
    s_mov_b64 exec, s[64:65]
    ds_read_b128 v[24:27], v2 offset:47104
    ds_read_b128 v[28:31], v2 offset:47360
    s_mov_b64 exec, -1
    v_exp_f32 v34, v34
    v_exp_f32 v35, v35
    v_exp_f32 v36, v36
    v_mfma_f32_32x32x16_bf16 v[48:63], v[20:23], v[16:19], 0
    ds_read_b128 v[20:23], v1 offset:2048
    v_exp_f32 v37, v37
    v_exp_f32 v38, v38
    v_exp_f32 v39, v39
    v_mfma_f32_32x32x16_bf16 v[80:95], v[112:115], v[220:223], v[80:95]
    ds_read_b64_tr_b16 v[112:113], v15 offset:29696
    ds_read_b64_tr_b16 v[114:115], v15 offset:29824
    v_exp_f32 v40, v40
    v_exp_f32 v41, v41
    v_exp_f32 v42, v42
    v_exp_f32 v43, v43
    s_waitcnt lgkmcnt(2)
    v_smfmac_f32_32x32x32_bf16 v[64:79], v[24:27], v[32:39], v0
    v_exp_f32 v44, v44
    v_exp_f32 v45, v45
    v_exp_f32 v46, v46
    v_mfma_f32_32x32x16_bf16 v[80:95], v[116:119], v[224:227], v[80:95]
    ds_read_b64_tr_b16 v[116:117], v15 offset:30208
    ds_read_b64_tr_b16 v[118:119], v15 offset:30336
    v_exp_f32 v47, v47
    s_setprio 3
    v_exp_f32 v48, v48
    v_exp_f32 v49, v49
    v_smfmac_f32_32x32x32_bf16 v[64:79], v[28:31], v[40:47], v0
    s_mov_b64 exec, s[64:65]
    ds_read_b128 v[24:27], v2 offset:0
    ds_read_b128 v[28:31], v2 offset:256
    s_mov_b64 exec, -1
    s_waitcnt vmcnt(0)
    v_cmp_gt_u32 vcc, 0x80, v11
    s_nop 0
    s_and_b32 s3, vcc_lo, 0x3
    s_cbranch_scc1 L_hp2_s_40
L_hp2_b_39:
    v_exp_f32 v50, v50
    v_exp_f32 v51, v51
    v_exp_f32 v52, v52
    v_mfma_f32_32x32x16_bf16 v[32:47], v[20:23], v[16:19], 0
    ds_read_b128 v[20:23], v1 offset:4096
    v_exp_f32 v53, v53
    v_exp_f32 v54, v54
    v_exp_f32 v55, v55
    v_exp_f32 v56, v56
    v_exp_f32 v57, v57
    s_waitcnt lgkmcnt(2)
    v_smfmac_f32_32x32x32_bf16 v[64:79], v[24:27], v[48:55], v0
    v_exp_f32 v58, v58
    v_exp_f32 v59, v59
    v_exp_f32 v60, v60
    v_exp_f32 v61, v61
    v_mfma_f32_32x32x16_bf16 v[80:95], v[120:123], v[228:231], v[80:95]
    ds_read_b64_tr_b16 v[120:121], v15 offset:40960
    ds_read_b64_tr_b16 v[122:123], v15 offset:41088
    v_exp_f32 v62, v62
    v_exp_f32 v63, v63
    v_exp_f32 v32, v32
    v_exp_f32 v33, v33
    s_mov_b32 m0, s58
    s_waitcnt lgkmcnt(2)
    v_smfmac_f32_32x32x32_bf16 v[64:79], v[28:31], v[56:63], v0
    s_mov_b64 exec, s[64:65]
    ds_read_b128 v[24:27], v2 offset:2048
    ds_read_b128 v[28:31], v2 offset:2304
    s_mov_b64 exec, -1
    buffer_load_dwordx4 v12, s[24:27], s75 offen lds
    v_exp_f32 v34, v34
    v_exp_f32 v35, v35
    v_exp_f32 v36, v36
    v_mfma_f32_32x32x16_bf16 v[48:63], v[20:23], v[16:19], 0
    ds_read_b128 v[20:23], v1 offset:6144
    buffer_load_dwordx4 v[128:131], v1, s[40:43], s74 offen offset:0 sc1
    v_exp_f32 v37, v37
    v_exp_f32 v38, v38
    v_exp_f32 v39, v39
    v_mfma_f32_32x32x16_bf16 v[80:95], v[112:115], v[232:235], v[80:95]
    ds_read_b64_tr_b16 v[112:113], v15 offset:41472
    ds_read_b64_tr_b16 v[114:115], v15 offset:41600
    buffer_load_dwordx4 v124, s[24:27], s75 offen offset:1024 lds
    s_add_u32 s75, s75, 32768
    v_exp_f32 v40, v40
    v_exp_f32 v41, v41
    v_exp_f32 v42, v42
    v_exp_f32 v43, v43
    s_waitcnt lgkmcnt(2)
    v_smfmac_f32_32x32x32_bf16 v[64:79], v[24:27], v[32:39], v0
    buffer_load_dwordx4 v[132:135], v1, s[40:43], s74 offen offset:1024 sc1
    v_exp_f32 v44, v44
    v_exp_f32 v45, v45
    v_exp_f32 v46, v46
    v_mfma_f32_32x32x16_bf16 v[80:95], v[116:119], v[236:239], v[80:95]
    ds_read_b64_tr_b16 v[116:117], v15 offset:41984
    ds_read_b64_tr_b16 v[118:119], v15 offset:42112
    ds_write_b32 v8, v8 offset:128
    v_exp_f32 v47, v47
    v_exp_f32 v48, v48
    v_exp_f32 v49, v49
    v_smfmac_f32_32x32x32_bf16 v[64:79], v[28:31], v[40:47], v0
    s_mov_b64 exec, s[64:65]
    ds_read_b128 v[24:27], v2 offset:4096
    ds_read_b128 v[28:31], v2 offset:4352
    s_mov_b64 exec, -1
    buffer_load_dwordx4 v[136:139], v1, s[40:43], s74 offen offset:2048 sc1
    v_exp_f32 v50, v50
    v_exp_f32 v51, v51
    v_exp_f32 v52, v52
    v_mfma_f32_32x32x16_bf16 v[32:47], v[20:23], v[16:19], 0
    ds_read_b128 v[20:23], v1 offset:8192
    v_exp_f32 v53, v53
    v_exp_f32 v54, v54
    v_exp_f32 v55, v55
    v_mfma_f32_32x32x16_bf16 v[80:95], v[120:123], v[240:243], v[80:95]
    ds_read_b64_tr_b16 v[120:121], v15 offset:42496
    ds_read_b64_tr_b16 v[122:123], v15 offset:42624
    buffer_load_dwordx4 v[140:143], v1, s[40:43], s74 offen offset:3072 sc1
    s_add_u32 s74, s74, 4096
    v_exp_f32 v56, v56
    v_exp_f32 v57, v57
    v_exp_f32 v58, v58
    v_exp_f32 v59, v59
    s_waitcnt lgkmcnt(2)
    v_smfmac_f32_32x32x32_bf16 v[64:79], v[24:27], v[48:55], v0
    ds_read_b64_tr_b16 v[160:161], v3 offset:8192
    v_exp_f32 v60, v60
    v_exp_f32 v61, v61
    v_exp_f32 v62, v62
    v_mfma_f32_32x32x16_bf16 v[80:95], v[112:115], v[244:247], v[80:95]
    ds_read_b64_tr_b16 v[162:163], v3 offset:9216
    v_exp_f32 v63, v63
    s_setprio 2
    v_exp_f32 v32, v32
    v_exp_f32 v33, v33
    v_smfmac_f32_32x32x32_bf16 v[64:79], v[28:31], v[56:63], v0
    s_mov_b64 exec, s[64:65]
    ds_read_b128 v[24:27], v2 offset:6144
    ds_read_b128 v[28:31], v2 offset:6400
    s_mov_b64 exec, -1
    v_mov_b32 v104, -1
    v_mov_b32 v105, -1
    v_mov_b32 v106, -1
    v_mov_b32 v107, -1
    buffer_store_dwordx4 v[104:107], v1, s[40:43], s73 offen sc1
    v_exp_f32 v34, v34
    v_exp_f32 v35, v35
    v_exp_f32 v36, v36
    v_mfma_f32_32x32x16_bf16 v[48:63], v[20:23], v[16:19], 0
    ds_read_b128 v[20:23], v1 offset:10240
    buffer_load_dwordx4 v[144:147], v1, s[40:43], s74 offen offset:0 sc1
    v_exp_f32 v37, v37
    v_exp_f32 v38, v38
    v_exp_f32 v39, v39
    v_mfma_f32_32x32x16_bf16 v[80:95], v[116:119], v[248:251], v[80:95]
    ds_read_b64_tr_b16 v[164:165], v5 offset:8192
    v_exp_f32 v40, v40
    v_exp_f32 v41, v41
    v_exp_f32 v42, v42
    v_exp_f32 v43, v43
    s_waitcnt lgkmcnt(2)
    v_smfmac_f32_32x32x32_bf16 v[64:79], v[24:27], v[32:39], v0
    ds_read_b64_tr_b16 v[166:167], v5 offset:9216
    buffer_load_dwordx4 v[148:151], v1, s[40:43], s74 offen offset:1024 sc1
    v_exp_f32 v44, v44
    v_exp_f32 v45, v45
    v_exp_f32 v46, v46
    v_mfma_f32_32x32x16_bf16 v[80:95], v[120:123], v[252:255], v[80:95]
    v_exp_f32 v47, v47
    v_exp_f32 v48, v48
    v_exp_f32 v49, v49
    s_add_u32 m0, s58, 2048
    v_smfmac_f32_32x32x32_bf16 v[64:79], v[28:31], v[40:47], v0
    s_mov_b64 exec, s[64:65]
    ds_read_b128 v[24:27], v2 offset:8192
    ds_read_b128 v[28:31], v2 offset:8448
    s_mov_b64 exec, -1
    buffer_load_dwordx4 v12, s[24:27], s75 offen lds
    v_exp_f32 v50, v50
    v_exp_f32 v51, v51
    v_exp_f32 v52, v52
    s_waitcnt lgkmcnt(2)
    v_mfma_f32_32x32x16_bf16 v[32:47], v[20:23], v[16:19], 0
    ds_read_b128 v[20:23], v1 offset:12288
    v_exp_f32 v53, v53
    v_exp_f32 v54, v54
    v_exp_f32 v55, v55
    v_exp_f32 v56, v56
    v_exp_f32 v57, v57
    s_waitcnt lgkmcnt(2)
    v_smfmac_f32_32x32x32_bf16 v[64:79], v[24:27], v[48:55], v0
    buffer_load_dwordx4 v124, s[24:27], s75 offen offset:1024 lds
    s_add_u32 s75, s75, 32768
    v_exp_f32 v58, v58
    v_mul_f32 v80, 0xbfb8aa3b, v80
    v_mul_f32 v81, 0xbfb8aa3b, v81
    v_exp_f32 v59, v59
    v_mul_f32 v82, 0xbfb8aa3b, v82
    v_exp_f32 v60, v60
    v_mul_f32 v83, 0xbfb8aa3b, v83
    v_exp_f32 v61, v61
    s_waitcnt vmcnt(7)
    v_mfma_f32_32x32x16_bf16 v[192:207], v[128:131], v[160:163], 0
    ds_read_b64_tr_b16 v[168:169], v3 offset:10240
    buffer_load_dwordx4 v[152:155], v1, s[40:43], s74 offen offset:2048 sc1
    v_exp_f32 v80, v80
    v_exp_f32 v62, v62
    v_exp_f32 v81, v81
    v_exp_f32 v82, v82
    v_exp_f32 v63, v63
    v_exp_f32 v83, v83
    v_exp_f32 v32, v32
    v_fma_f32 v80, v80, v6, v6
    v_exp_f32 v33, v33
    s_waitcnt lgkmcnt(2)
    v_smfmac_f32_32x32x32_bf16 v[64:79], v[28:31], v[56:63], v0
    s_mov_b64 exec, s[64:65]
    ds_read_b128 v[24:27], v2 offset:10240
    ds_read_b128 v[28:31], v2 offset:10496
    s_mov_b64 exec, -1
    ds_read_b32 v10, v9 offset:128
    v_fma_f32 v81, v81, v6, v6
    v_exp_f32 v34, v34
    v_fma_f32 v82, v82, v6, v6
    v_fma_f32 v83, v83, v6, v6
    v_exp_f32 v35, v35
    v_rcp_f32 v80, v80
    v_exp_f32 v36, v36
    s_waitcnt lgkmcnt(2)
    v_mfma_f32_32x32x16_bf16 v[48:63], v[20:23], v[16:19], 0
    ds_read_b128 v[20:23], v1 offset:14336
    s_waitcnt lgkmcnt(1)
    v_cmp_eq_u32 vcc, 0, v10
    s_cbranch_vccnz L_ep_s_42
L_ep_b_41:
    v_rcp_f32 v81, v81
    v_exp_f32 v37, v37
    v_rcp_f32 v82, v82
    v_exp_f32 v38, v38
    v_rcp_f32 v83, v83
    v_mul_f32 v84, 0xbfb8aa3b, v84
    v_exp_f32 v39, v39
    v_mul_f32 v85, 0xbfb8aa3b, v85
    v_exp_f32 v40, v40
    v_mul_f32 v86, 0xbfb8aa3b, v86
    v_exp_f32 v41, v41
    v_smfmac_f32_32x32x32_bf16 v[64:79], v[24:27], v[32:39], v0
    s_add_u32 m0, s62, 32768
    s_add_u32 s82, s54, 5
    s_and_b32 s82, s82, 7
    s_lshl_b32 s82, s82, 14
    s_add_u32 s69, s82, s70
    buffer_load_dwordx4 v1, s[40:43], s69 offen sc1 lds
    v_mul_f32 v87, 0xbfb8aa3b, v87
    v_exp_f32 v42, v42
    v_exp_f32 v84, v84
    v_exp_f32 v85, v85
    v_exp_f32 v43, v43
    v_exp_f32 v86, v86
    v_exp_f32 v44, v44
    v_exp_f32 v87, v87
    v_exp_f32 v45, v45
    v_mfma_f32_32x32x16_bf16 v[224:239], v[132:135], v[160:163], 0
    ds_read_b64_tr_b16 v[170:171], v3 offset:11264
    buffer_load_dwordx4 v[156:159], v1, s[40:43], s74 offen offset:3072 sc1
    s_add_u32 s74, s74, 4096
    buffer_load_dwordx4 v1, s[40:43], s69 offen offset:1024 sc1 lds
    v_fma_f32 v84, v84, v6, v6
    v_exp_f32 v46, v46
    v_fma_f32 v85, v85, v6, v6
    v_fma_f32 v86, v86, v6, v6
    v_exp_f32 v47, v47
    s_setprio 1
    v_fma_f32 v87, v87, v6, v6
    v_exp_f32 v48, v48
    v_rcp_f32 v84, v84
    v_exp_f32 v49, v49
    v_smfmac_f32_32x32x32_bf16 v[64:79], v[28:31], v[40:47], v0
    s_mov_b64 exec, s[64:65]
    ds_read_b128 v[24:27], v2 offset:12288
    ds_read_b128 v[28:31], v2 offset:12544
    s_mov_b64 exec, -1
    v_rcp_f32 v85, v85
    v_exp_f32 v50, v50
    v_rcp_f32 v86, v86
    v_rcp_f32 v87, v87
    v_exp_f32 v51, v51
    v_pk_mul_f32 v[80:81], v[80:81], v[88:89]
    v_exp_f32 v52, v52
    s_waitcnt lgkmcnt(2)
    v_mfma_f32_32x32x16_bf16 v[32:47], v[20:23], v[16:19], 0
    ds_read_b128 v[20:23], v1 offset:16384
    v_pk_mul_f32 v[82:83], v[82:83], v[90:91]
    v_exp_f32 v53, v53
    v_pk_mul_f32 v[84:85], v[84:85], v[92:93]
    v_exp_f32 v54, v54
    v_pk_mul_f32 v[86:87], v[86:87], v[94:95]
    v_cvt_pk_bf16_f32 v80, v80, v81
    v_exp_f32 v55, v55
    s_add_u32 m0, s58, 8192
    v_mfma_f32_32x32x16_bf16 v[208:223], v[128:131], v[164:167], 0
    ds_read_b64_tr_b16 v[172:173], v5 offset:10240
    buffer_load_dwordx4 v12, s[24:27], s75 offen lds
    v_cvt_pk_bf16_f32 v81, v82, v83
    v_exp_f32 v56, v56
    v_cvt_pk_bf16_f32 v82, v84, v85
    v_exp_f32 v57, v57
    v_cvt_pk_bf16_f32 v83, v86, v87
    v_exp_f32 v58, v58
    v_exp_f32 v59, v59
    s_waitcnt lgkmcnt(2)
    v_smfmac_f32_32x32x32_bf16 v[64:79], v[24:27], v[48:55], v0
    s_and_b32 s3, s57, 1
    s_mul_i32 s3, s3, 14
    s_lshr_b32 s81, s57, 1
    s_add_u32 s3, s3, s81
    s_add_u32 s3, s3, 10
    s_lshl_b32 s3, s3, 11
    s_add_u32 s61, s3, s78
    buffer_store_dwordx4 v[80:83], v1, s[40:43], s61 offen sc1
    v_exp_f32 v60, v60
    v_exp_f32 v61, v61
    v_exp_f32 v62, v62
    v_mfma_f32_32x32x16_bf16 v[240:255], v[132:135], v[164:167], 0
    ds_read_b64_tr_b16 v[174:175], v5 offset:11264
    buffer_load_dwordx4 v124, s[24:27], s75 offen offset:1024 lds
    s_add_u32 s75, s75, 32768
    v_exp_f32 v63, v63
    s_setprio 0
    v_exp_f32 v32, v32
    v_exp_f32 v33, v33
    v_smfmac_f32_32x32x32_bf16 v[64:79], v[28:31], v[56:63], v0
    s_mov_b64 exec, s[64:65]
    ds_read_b128 v[24:27], v2 offset:14336
    ds_read_b128 v[28:31], v2 offset:14592
    s_mov_b64 exec, -1
    v_exp_f32 v34, v34
    v_exp_f32 v35, v35
    v_exp_f32 v36, v36
    s_waitcnt lgkmcnt(2)
    v_mfma_f32_32x32x16_bf16 v[48:63], v[20:23], v[16:19], 0
    ds_read_b128 v[20:23], v1 offset:18432
    v_exp_f32 v37, v37
    v_exp_f32 v38, v38
    v_exp_f32 v39, v39
    v_exp_f32 v40, v40
    v_exp_f32 v41, v41
    s_waitcnt lgkmcnt(2)
    v_smfmac_f32_32x32x32_bf16 v[64:79], v[24:27], v[32:39], v0
    v_exp_f32 v42, v42
    v_exp_f32 v43, v43
    v_exp_f32 v44, v44
    v_exp_f32 v45, v45
    s_waitcnt vmcnt(12)
    v_mfma_f32_32x32x16_bf16 v[192:207], v[136:139], v[168:171], v[192:207]
    ds_read_b64_tr_b16 v[160:161], v3 offset:0
    buffer_load_dwordx4 v[176:179], v1, s[40:43], s74 offen offset:0 sc1
    v_exp_f32 v46, v46
    v_exp_f32 v47, v47
    s_setprio 3
    v_exp_f32 v48, v48
    v_exp_f32 v49, v49
    s_waitcnt lgkmcnt(2)
    v_smfmac_f32_32x32x32_bf16 v[64:79], v[28:31], v[40:47], v0
    s_mov_b64 exec, s[64:65]
    ds_read_b128 v[24:27], v2 offset:16384
    ds_read_b128 v[28:31], v2 offset:16640
    s_mov_b64 exec, -1
    v_exp_f32 v50, v50
    v_exp_f32 v51, v51
    v_exp_f32 v52, v52
    s_waitcnt lgkmcnt(2)
    v_mfma_f32_32x32x16_bf16 v[32:47], v[20:23], v[16:19], 0
    ds_read_b128 v[20:23], v1 offset:20480
    v_exp_f32 v53, v53
    v_exp_f32 v54, v54
    v_exp_f32 v55, v55
    v_exp_f32 v56, v56
    v_exp_f32 v57, v57
    s_waitcnt lgkmcnt(2)
    v_smfmac_f32_32x32x32_bf16 v[64:79], v[24:27], v[48:55], v0
    v_exp_f32 v58, v58
    v_exp_f32 v59, v59
    v_exp_f32 v60, v60
    v_exp_f32 v61, v61
    v_mfma_f32_32x32x16_bf16 v[224:239], v[140:143], v[168:171], v[224:239]
    ds_read_b64_tr_b16 v[162:163], v3 offset:1024
    buffer_load_dwordx4 v[180:183], v1, s[40:43], s74 offen offset:1024 sc1
    v_exp_f32 v62, v62
    v_exp_f32 v63, v63
    v_exp_f32 v32, v32
    v_exp_f32 v33, v33
    s_waitcnt lgkmcnt(2)
    v_smfmac_f32_32x32x32_bf16 v[64:79], v[28:31], v[56:63], v0
    s_mov_b64 exec, s[64:65]
    ds_read_b128 v[24:27], v2 offset:18432
    ds_read_b128 v[28:31], v2 offset:18688
    s_mov_b64 exec, -1
    v_exp_f32 v34, v34
    v_exp_f32 v35, v35
    v_exp_f32 v36, v36
    s_waitcnt lgkmcnt(2)
    v_mfma_f32_32x32x16_bf16 v[48:63], v[20:23], v[16:19], 0
    ds_read_b128 v[20:23], v1 offset:22528
    v_exp_f32 v37, v37
    v_exp_f32 v38, v38
    v_exp_f32 v39, v39
    s_add_u32 m0, s58, 10240
    v_mfma_f32_32x32x16_bf16 v[208:223], v[136:139], v[172:175], v[208:223]
    ds_read_b64_tr_b16 v[164:165], v5 offset:0
    buffer_load_dwordx4 v12, s[24:27], s75 offen lds
    v_exp_f32 v40, v40
    v_exp_f32 v41, v41
    v_exp_f32 v42, v42
    v_exp_f32 v43, v43
    s_waitcnt lgkmcnt(2)
    v_smfmac_f32_32x32x32_bf16 v[64:79], v[24:27], v[32:39], v0
    s_waitcnt vmcnt(6)
    ds_write_b32 v8, v8 offset:160
    v_exp_f32 v44, v44
    v_exp_f32 v45, v45
    v_exp_f32 v46, v46
    v_mfma_f32_32x32x16_bf16 v[240:255], v[140:143], v[172:175], v[240:255]
    ds_read_b64_tr_b16 v[166:167], v5 offset:1024
    buffer_load_dwordx4 v124, s[24:27], s75 offen offset:1024 lds
    s_add_u32 s75, s75, 32768
    v_exp_f32 v47, v47
    v_exp_f32 v48, v48
    v_exp_f32 v49, v49
    v_smfmac_f32_32x32x32_bf16 v[64:79], v[28:31], v[40:47], v0
    s_mov_b64 exec, s[64:65]
    ds_read_b128 v[24:27], v2 offset:20480
    ds_read_b128 v[28:31], v2 offset:20736
    s_mov_b64 exec, -1
    v_exp_f32 v50, v50
    v_exp_f32 v51, v51
    v_exp_f32 v52, v52
    s_waitcnt lgkmcnt(2)
    v_mfma_f32_32x32x16_bf16 v[32:47], v[20:23], v[16:19], 0
    ds_read_b128 v[20:23], v1 offset:24576
    v_exp_f32 v53, v53
    v_exp_f32 v54, v54
    v_exp_f32 v55, v55
    v_exp_f32 v56, v56
    v_exp_f32 v57, v57
    s_waitcnt lgkmcnt(2)
    v_smfmac_f32_32x32x32_bf16 v[64:79], v[24:27], v[48:55], v0
    v_exp_f32 v58, v58
    v_exp_f32 v59, v59
    v_exp_f32 v60, v60
    v_exp_f32 v61, v61
    v_mfma_f32_32x32x16_bf16 v[192:207], v[144:147], v[160:163], v[192:207]
    ds_read_b64_tr_b16 v[168:169], v3 offset:2048
    buffer_load_dwordx4 v[184:187], v1, s[40:43], s74 offen offset:2048 sc1
    v_exp_f32 v62, v62
    v_exp_f32 v63, v63
    s_setprio 2
    v_exp_f32 v32, v32
    v_exp_f32 v33, v33
    s_waitcnt lgkmcnt(2)
    v_smfmac_f32_32x32x32_bf16 v[64:79], v[28:31], v[56:63], v0
    s_mov_b64 exec, s[64:65]
    ds_read_b128 v[24:27], v2 offset:22528
    ds_read_b128 v[28:31], v2 offset:22784
    s_mov_b64 exec, -1
    v_exp_f32 v34, v34
    v_exp_f32 v35, v35
    v_exp_f32 v36, v36
    s_waitcnt lgkmcnt(2)
    v_mfma_f32_32x32x16_bf16 v[48:63], v[20:23], v[16:19], 0
    ds_read_b128 v[20:23], v1 offset:26624
    v_exp_f32 v37, v37
    v_exp_f32 v38, v38
    v_exp_f32 v39, v39
    v_exp_f32 v40, v40
    v_exp_f32 v41, v41
    s_waitcnt lgkmcnt(2)
    v_smfmac_f32_32x32x32_bf16 v[64:79], v[24:27], v[32:39], v0
    v_exp_f32 v42, v42
    v_exp_f32 v43, v43
    v_exp_f32 v44, v44
    v_exp_f32 v45, v45
    v_mfma_f32_32x32x16_bf16 v[224:239], v[148:151], v[160:163], v[224:239]
    ds_read_b64_tr_b16 v[170:171], v3 offset:3072
    buffer_load_dwordx4 v[188:191], v1, s[40:43], s74 offen offset:3072 sc1
    s_add_u32 s74, s74, 4096
    v_exp_f32 v46, v46
    v_exp_f32 v47, v47
    v_exp_f32 v48, v48
    v_exp_f32 v49, v49
    s_waitcnt lgkmcnt(2)
    v_smfmac_f32_32x32x32_bf16 v[64:79], v[28:31], v[40:47], v0
    s_mov_b64 exec, s[64:65]
    ds_read_b128 v[24:27], v2 offset:24576
    ds_read_b128 v[28:31], v2 offset:24832
    s_mov_b64 exec, -1
    v_exp_f32 v50, v50
    v_exp_f32 v51, v51
    v_exp_f32 v52, v52
    s_waitcnt lgkmcnt(2)
    v_mfma_f32_32x32x16_bf16 v[32:47], v[20:23], v[16:19], 0
    ds_read_b128 v[20:23], v1 offset:28672
    v_exp_f32 v53, v53
    v_exp_f32 v54, v54
    v_exp_f32 v55, v55
    s_mov_b32 m0, s58
    v_mfma_f32_32x32x16_bf16 v[208:223], v[144:147], v[164:167], v[208:223]
    ds_read_b64_tr_b16 v[172:173], v5 offset:2048
    buffer_load_dwordx4 v12, s[24:27], s75 offen lds
    v_exp_f32 v56, v56
    v_exp_f32 v57, v57
    v_exp_f32 v58, v58
    v_exp_f32 v59, v59
    s_waitcnt lgkmcnt(2)
    v_smfmac_f32_32x32x32_bf16 v[64:79], v[24:27], v[48:55], v0
    s_waitcnt vmcnt(8)
    s_mov_b64 exec, 2
    buffer_atomic_add v1, off, s[40:43], s71 offset:8 sc1
    s_mov_b64 exec, -1
    v_exp_f32 v60, v60
    v_exp_f32 v61, v61
    v_exp_f32 v62, v62
    v_mfma_f32_32x32x16_bf16 v[240:255], v[148:151], v[164:167], v[240:255]
    ds_read_b64_tr_b16 v[174:175], v5 offset:3072
    buffer_load_dwordx4 v124, s[24:27], s75 offen offset:1024 lds
    s_add_u32 s75, s75, 32768
    v_exp_f32 v63, v63
    v_exp_f32 v32, v32
    v_exp_f32 v33, v33
    v_smfmac_f32_32x32x32_bf16 v[64:79], v[28:31], v[56:63], v0
    s_mov_b64 exec, s[64:65]
    ds_read_b128 v[24:27], v2 offset:26624
    ds_read_b128 v[28:31], v2 offset:26880
    s_mov_b64 exec, -1
    ds_read_b32 v10, v9 offset:160
    v_exp_f32 v34, v34
    v_exp_f32 v35, v35
    v_exp_f32 v36, v36
    s_waitcnt lgkmcnt(2)
    v_mfma_f32_32x32x16_bf16 v[48:63], v[20:23], v[16:19], 0
    ds_read_b128 v[20:23], v1 offset:30720
    s_waitcnt lgkmcnt(1)
    v_cmp_eq_u32 vcc, 0, v10
    s_cbranch_vccnz L_ep_s_44
L_ep_b_43:
    v_exp_f32 v37, v37
    v_exp_f32 v38, v38
    v_exp_f32 v39, v39
    v_exp_f32 v40, v40
    v_exp_f32 v41, v41
    v_smfmac_f32_32x32x32_bf16 v[64:79], v[24:27], v[32:39], v0
    s_mov_b32 m0, s62
    s_add_u32 s82, s54, 6
    s_and_b32 s82, s82, 7
    s_lshl_b32 s82, s82, 14
    s_add_u32 s69, s82, s70
    buffer_load_dwordx4 v1, s[40:43], s69 offen sc1 lds
    v_exp_f32 v42, v42
    v_exp_f32 v43, v43
    v_exp_f32 v44, v44
    v_exp_f32 v45, v45
    s_waitcnt vmcnt(10)
    v_mfma_f32_32x32x16_bf16 v[192:207], v[152:155], v[168:171], v[192:207]
    ds_read_b64_tr_b16 v[160:161], v3 offset:8192
    buffer_load_dwordx4 v[128:131], v1, s[40:43], s74 offen offset:0 sc1
    buffer_load_dwordx4 v1, s[40:43], s69 offen offset:1024 sc1 lds
    v_exp_f32 v46, v46
    v_exp_f32 v47, v47
    s_setprio 1
    v_exp_f32 v48, v48
    v_exp_f32 v49, v49
    v_smfmac_f32_32x32x32_bf16 v[64:79], v[28:31], v[40:47], v0
    s_mov_b64 exec, s[64:65]
    ds_read_b128 v[24:27], v2 offset:28672
    ds_read_b128 v[28:31], v2 offset:28928
    s_mov_b64 exec, -1
    v_exp_f32 v50, v50
    v_exp_f32 v51, v51
    v_exp_f32 v52, v52
    s_waitcnt lgkmcnt(2)
    v_mfma_f32_32x32x16_bf16 v[32:47], v[20:23], v[16:19], 0
    ds_read_b128 v[20:23], v1 offset:32768
    v_exp_f32 v53, v53
    v_exp_f32 v54, v54
    v_exp_f32 v55, v55
    v_mfma_f32_32x32x16_bf16 v[224:239], v[156:159], v[168:171], v[224:239]
    ds_read_b64_tr_b16 v[162:163], v3 offset:9216
    buffer_load_dwordx4 v[132:135], v1, s[40:43], s74 offen offset:1024 sc1
    v_exp_f32 v56, v56
    v_exp_f32 v57, v57
    v_exp_f32 v58, v58
    v_exp_f32 v59, v59
    s_waitcnt lgkmcnt(2)
    v_smfmac_f32_32x32x32_bf16 v[64:79], v[24:27], v[48:55], v0
    v_exp_f32 v60, v60
    v_exp_f32 v61, v61
    v_exp_f32 v62, v62
    s_add_u32 m0, s58, 2048
    v_mfma_f32_32x32x16_bf16 v[208:223], v[152:155], v[172:175], v[208:223]
    ds_read_b64_tr_b16 v[164:165], v5 offset:8192
    buffer_load_dwordx4 v12, s[24:27], s75 offen lds
    v_exp_f32 v63, v63
    s_setprio 0
    v_exp_f32 v32, v32
    v_exp_f32 v33, v33
    v_smfmac_f32_32x32x32_bf16 v[64:79], v[28:31], v[56:63], v0
    s_mov_b64 exec, s[64:65]
    ds_read_b128 v[24:27], v2 offset:30720
    ds_read_b128 v[28:31], v2 offset:30976
    s_mov_b64 exec, -1
    v_exp_f32 v34, v34
    v_exp_f32 v35, v35
    v_exp_f32 v36, v36
    s_waitcnt lgkmcnt(2)
    v_mfma_f32_32x32x16_bf16 v[48:63], v[20:23], v[16:19], 0
    ds_read_b128 v[20:23], v1 offset:34816
    v_exp_f32 v37, v37
    v_exp_f32 v38, v38
    v_exp_f32 v39, v39
    v_exp_f32 v40, v40
    v_exp_f32 v41, v41
    s_waitcnt lgkmcnt(2)
    v_smfmac_f32_32x32x32_bf16 v[64:79], v[24:27], v[32:39], v0
    v_exp_f32 v42, v42
    v_exp_f32 v43, v43
    v_exp_f32 v44, v44
    v_exp_f32 v45, v45
    v_mfma_f32_32x32x16_bf16 v[240:255], v[156:159], v[172:175], v[240:255]
    ds_read_b64_tr_b16 v[166:167], v5 offset:9216
    buffer_load_dwordx4 v124, s[24:27], s75 offen offset:1024 lds
    s_add_u32 s75, s75, 32768
    v_exp_f32 v46, v46
    v_exp_f32 v47, v47
    s_setprio 3
    v_exp_f32 v48, v48
    v_exp_f32 v49, v49
    s_waitcnt lgkmcnt(2)
    v_smfmac_f32_32x32x32_bf16 v[64:79], v[28:31], v[40:47], v0
    s_mov_b64 exec, s[64:65]
    ds_read_b128 v[24:27], v2 offset:32768
    ds_read_b128 v[28:31], v2 offset:33024
    s_mov_b64 exec, -1
    v_exp_f32 v50, v50
    v_exp_f32 v51, v51
    v_exp_f32 v52, v52
    s_waitcnt lgkmcnt(2)
    v_mfma_f32_32x32x16_bf16 v[32:47], v[20:23], v[16:19], 0
    ds_read_b128 v[20:23], v1 offset:36864
    v_exp_f32 v53, v53
    v_exp_f32 v54, v54
    v_exp_f32 v55, v55
    v_exp_f32 v56, v56
    v_exp_f32 v57, v57
    s_waitcnt lgkmcnt(2)
    v_smfmac_f32_32x32x32_bf16 v[64:79], v[24:27], v[48:55], v0
    v_exp_f32 v58, v58
    v_exp_f32 v59, v59
    v_exp_f32 v60, v60
    v_exp_f32 v61, v61
    s_waitcnt vmcnt(11)
    v_mfma_f32_32x32x16_bf16 v[192:207], v[176:179], v[160:163], v[192:207]
    ds_read_b64_tr_b16 v[168:169], v3 offset:10240
    buffer_load_dwordx4 v[136:139], v1, s[40:43], s74 offen offset:2048 sc1
    v_exp_f32 v62, v62
    v_exp_f32 v63, v63
    v_exp_f32 v32, v32
    v_exp_f32 v33, v33
    s_waitcnt lgkmcnt(2)
    v_smfmac_f32_32x32x32_bf16 v[64:79], v[28:31], v[56:63], v0
    s_mov_b64 exec, s[64:65]
    ds_read_b128 v[24:27], v2 offset:34816
    ds_read_b128 v[28:31], v2 offset:35072
    s_mov_b64 exec, -1
    v_exp_f32 v34, v34
    v_exp_f32 v35, v35
    v_exp_f32 v36, v36
    s_waitcnt lgkmcnt(2)
    v_mfma_f32_32x32x16_bf16 v[48:63], v[20:23], v[16:19], 0
    ds_read_b128 v[20:23], v1 offset:38912
    v_exp_f32 v37, v37
    v_exp_f32 v38, v38
    v_exp_f32 v39, v39
    v_mfma_f32_32x32x16_bf16 v[224:239], v[180:183], v[160:163], v[224:239]
    ds_read_b64_tr_b16 v[170:171], v3 offset:11264
    buffer_load_dwordx4 v[140:143], v1, s[40:43], s74 offen offset:3072 sc1
    s_add_u32 s74, s74, 4096
    v_exp_f32 v40, v40
    v_exp_f32 v41, v41
    v_exp_f32 v42, v42
    v_exp_f32 v43, v43
    s_waitcnt lgkmcnt(2)
    v_smfmac_f32_32x32x32_bf16 v[64:79], v[24:27], v[32:39], v0
    s_waitcnt vmcnt(5)
    ds_write_b32 v8, v8 offset:192
    v_exp_f32 v44, v44
    v_exp_f32 v45, v45
    v_exp_f32 v46, v46
    s_add_u32 m0, s58, 8192
    v_mfma_f32_32x32x16_bf16 v[208:223], v[176:179], v[164:167], v[208:223]
    ds_read_b64_tr_b16 v[172:173], v5 offset:10240
    buffer_load_dwordx4 v12, s[24:27], s75 offen lds
    v_exp_f32 v47, v47
    v_exp_f32 v48, v48
    v_exp_f32 v49, v49
    v_smfmac_f32_32x32x32_bf16 v[64:79], v[28:31], v[40:47], v0
    s_mov_b64 exec, s[64:65]
    ds_read_b128 v[24:27], v2 offset:36864
    ds_read_b128 v[28:31], v2 offset:37120
    s_mov_b64 exec, -1
    v_exp_f32 v50, v50
    v_exp_f32 v51, v51
    v_exp_f32 v52, v52
    s_waitcnt lgkmcnt(2)
    v_mfma_f32_32x32x16_bf16 v[32:47], v[20:23], v[16:19], 0
    ds_read_b128 v[20:23], v1 offset:40960
    v_exp_f32 v53, v53
    v_exp_f32 v54, v54
    v_exp_f32 v55, v55
    v_exp_f32 v56, v56
    v_exp_f32 v57, v57
    s_waitcnt lgkmcnt(2)
    v_smfmac_f32_32x32x32_bf16 v[64:79], v[24:27], v[48:55], v0
    v_exp_f32 v58, v58
    v_exp_f32 v59, v59
    v_exp_f32 v60, v60
    v_exp_f32 v61, v61
    v_mfma_f32_32x32x16_bf16 v[240:255], v[180:183], v[164:167], v[240:255]
    ds_read_b64_tr_b16 v[174:175], v5 offset:11264
    buffer_load_dwordx4 v124, s[24:27], s75 offen offset:1024 lds
    s_add_u32 s75, s75, 32768
    v_exp_f32 v62, v62
    v_exp_f32 v63, v63
    s_setprio 2
    v_exp_f32 v32, v32
    v_exp_f32 v33, v33
    s_waitcnt lgkmcnt(2)
    v_smfmac_f32_32x32x32_bf16 v[64:79], v[28:31], v[56:63], v0
    s_mov_b64 exec, s[64:65]
    ds_read_b128 v[24:27], v2 offset:38912
    ds_read_b128 v[28:31], v2 offset:39168
    s_mov_b64 exec, -1
    v_exp_f32 v34, v34
    v_exp_f32 v35, v35
    v_exp_f32 v36, v36
    s_waitcnt lgkmcnt(2)
    v_mfma_f32_32x32x16_bf16 v[48:63], v[20:23], v[16:19], 0
    ds_read_b128 v[20:23], v1 offset:43008
    v_exp_f32 v37, v37
    v_exp_f32 v38, v38
    v_exp_f32 v39, v39
    v_exp_f32 v40, v40
    v_exp_f32 v41, v41
    s_waitcnt lgkmcnt(2)
    v_smfmac_f32_32x32x32_bf16 v[64:79], v[24:27], v[32:39], v0
    v_exp_f32 v42, v42
    v_exp_f32 v43, v43
    v_exp_f32 v44, v44
    v_exp_f32 v45, v45
    v_mfma_f32_32x32x16_bf16 v[192:207], v[184:187], v[168:171], v[192:207]
    ds_read_b64_tr_b16 v[160:161], v3 offset:0
    buffer_load_dwordx4 v[144:147], v1, s[40:43], s74 offen offset:0 sc1
    v_exp_f32 v46, v46
    v_exp_f32 v47, v47
    v_exp_f32 v48, v48
    v_exp_f32 v49, v49
    s_waitcnt lgkmcnt(2)
    v_smfmac_f32_32x32x32_bf16 v[64:79], v[28:31], v[40:47], v0
    s_mov_b64 exec, s[64:65]
    ds_read_b128 v[24:27], v2 offset:40960
    ds_read_b128 v[28:31], v2 offset:41216
    s_mov_b64 exec, -1
    v_exp_f32 v50, v50
    v_exp_f32 v51, v51
    v_exp_f32 v52, v52
    s_waitcnt lgkmcnt(2)
    v_mfma_f32_32x32x16_bf16 v[32:47], v[20:23], v[16:19], 0
    ds_read_b128 v[20:23], v1 offset:45056
    v_exp_f32 v53, v53
    v_exp_f32 v54, v54
    v_exp_f32 v55, v55
    v_mfma_f32_32x32x16_bf16 v[224:239], v[188:191], v[168:171], v[224:239]
    ds_read_b64_tr_b16 v[162:163], v3 offset:1024
    buffer_load_dwordx4 v[148:151], v1, s[40:43], s74 offen offset:1024 sc1
    v_exp_f32 v56, v56
    v_exp_f32 v57, v57
    v_exp_f32 v58, v58
    v_exp_f32 v59, v59
    s_waitcnt lgkmcnt(2)
    v_smfmac_f32_32x32x32_bf16 v[64:79], v[24:27], v[48:55], v0
    ds_read_b32 v10, v9 offset:192
    v_exp_f32 v60, v60
    v_exp_f32 v61, v61
    v_exp_f32 v62, v62
    s_add_u32 m0, s58, 10240
    v_mfma_f32_32x32x16_bf16 v[208:223], v[184:187], v[172:175], v[208:223]
    ds_read_b64_tr_b16 v[164:165], v5 offset:0
    buffer_load_dwordx4 v12, s[24:27], s75 offen lds
    v_exp_f32 v63, v63
    v_exp_f32 v32, v32
    v_exp_f32 v33, v33
    v_smfmac_f32_32x32x32_bf16 v[64:79], v[28:31], v[56:63], v0
    s_mov_b64 exec, s[64:65]
    ds_read_b128 v[24:27], v2 offset:43008
    ds_read_b128 v[28:31], v2 offset:43264
    s_mov_b64 exec, -1
    s_waitcnt lgkmcnt(2)
    v_cmp_eq_u32 vcc, 0, v10
    s_cbranch_vccnz L_ep_s_46
L_ep_b_45:
    v_exp_f32 v34, v34
    v_exp_f32 v35, v35
    v_exp_f32 v36, v36
    v_mfma_f32_32x32x16_bf16 v[48:63], v[20:23], v[16:19], 0
    ds_read_b128 v[20:23], v1 offset:47104
    s_add_u32 m0, s62, 16384
    s_add_u32 s82, s54, 7
    s_and_b32 s82, s82, 7
    s_lshl_b32 s82, s82, 14
    s_add_u32 s69, s82, s70
    buffer_load_dwordx4 v1, s[40:43], s69 offen sc1 lds
    v_exp_f32 v37, v37
    v_exp_f32 v38, v38
    v_exp_f32 v39, v39
    v_exp_f32 v40, v40
    v_exp_f32 v41, v41
    s_waitcnt lgkmcnt(2)
    v_smfmac_f32_32x32x32_bf16 v[64:79], v[24:27], v[32:39], v0
    buffer_load_dwordx4 v1, s[40:43], s69 offen offset:1024 sc1 lds
    v_exp_f32 v42, v42
    v_exp_f32 v43, v43
    v_exp_f32 v44, v44
    v_exp_f32 v45, v45
    v_mfma_f32_32x32x16_bf16 v[240:255], v[188:191], v[172:175], v[240:255]
    ds_read_b64_tr_b16 v[166:167], v5 offset:1024
    s_add_u32 m0, s58, 10240
    s_nop 0
    buffer_load_dwordx4 v124, s[24:27], s75 offen offset:1024 lds
    s_add_u32 s75, s75, 32768
    v_exp_f32 v46, v46
    v_exp_f32 v47, v47
    s_setprio 1
    v_exp_f32 v48, v48
    v_exp_f32 v49, v49
    s_waitcnt lgkmcnt(2)
    v_smfmac_f32_32x32x32_bf16 v[64:79], v[28:31], v[40:47], v0
    s_mov_b64 exec, s[64:65]
    ds_read_b128 v[24:27], v2 offset:45056
    ds_read_b128 v[28:31], v2 offset:45312
    s_mov_b64 exec, -1
    v_mov_b32 v11, 0
    s_mov_b64 exec, 0x3
    buffer_atomic_or v11, v13, s[40:43], s72 offen offset:8 sc0 sc1
    s_mov_b64 exec, -1
    v_exp_f32 v50, v50
    v_exp_f32 v51, v51
    v_exp_f32 v52, v52
    s_waitcnt lgkmcnt(2)
    v_mfma_f32_32x32x16_bf16 v[32:47], v[20:23], v[16:19], 0
    ds_read_b128 v[20:23], v1 offset:0
    v_exp_f32 v53, v53
    v_exp_f32 v54, v54
    v_exp_f32 v55, v55
    s_waitcnt vmcnt(11)
    v_mfma_f32_32x32x16_bf16 v[192:207], v[128:131], v[160:163], v[192:207]
    ds_read_b64_tr_b16 v[168:169], v3 offset:2048
    buffer_load_dwordx4 v[152:155], v1, s[40:43], s74 offen offset:2048 sc1
    v_exp_f32 v56, v56
    v_exp_f32 v57, v57
    v_exp_f32 v58, v58
    v_exp_f32 v59, v59
    s_waitcnt lgkmcnt(2)
    v_smfmac_f32_32x32x32_bf16 v[64:79], v[24:27], v[48:55], v0
    v_exp_f32 v60, v60
    v_exp_f32 v61, v61
    v_exp_f32 v62, v62
    v_mfma_f32_32x32x16_bf16 v[224:239], v[132:135], v[160:163], v[224:239]
    ds_read_b64_tr_b16 v[170:171], v3 offset:3072
    buffer_load_dwordx4 v[156:159], v1, s[40:43], s74 offen offset:3072 sc1
    s_add_u32 s74, s74, 4096
    v_exp_f32 v63, v63
    s_setprio 0
    v_exp_f32 v32, v32
    v_exp_f32 v33, v33
    v_smfmac_f32_32x32x32_bf16 v[64:79], v[28:31], v[56:63], v0
    s_mov_b64 exec, s[64:65]
    ds_read_b128 v[24:27], v2 offset:47104
    ds_read_b128 v[28:31], v2 offset:47360
    s_mov_b64 exec, -1
    v_exp_f32 v34, v34
    v_exp_f32 v35, v35
    v_exp_f32 v36, v36
    s_waitcnt lgkmcnt(2)
    v_mfma_f32_32x32x16_bf16 v[48:63], v[20:23], v[16:19], 0
    ds_read_b128 v[20:23], v1 offset:2048
    v_exp_f32 v37, v37
    v_exp_f32 v38, v38
    v_exp_f32 v39, v39
    v_exp_f32 v40, v40
    v_exp_f32 v41, v41
    s_waitcnt lgkmcnt(2)
    v_smfmac_f32_32x32x32_bf16 v[64:79], v[24:27], v[32:39], v0
    s_waitcnt vmcnt(2)
    v_cmp_gt_u32 vcc, 0x80, v11
    s_nop 0
    s_and_b32 s3, vcc_lo, 0x3
    s_cbranch_scc1 L_hp3_s_48
L_hp3_b_47:
    v_exp_f32 v42, v42
    v_exp_f32 v43, v43
    v_exp_f32 v44, v44
    v_exp_f32 v45, v45
    s_mov_b32 m0, s58
    v_mfma_f32_32x32x16_bf16 v[208:223], v[128:131], v[164:167], v[208:223]
    ds_read_b64_tr_b16 v[172:173], v5 offset:2048
    buffer_load_dwordx4 v12, s[24:27], s75 offen lds
    v_exp_f32 v46, v46
    v_exp_f32 v47, v47
    s_setprio 3
    v_exp_f32 v48, v48
    v_exp_f32 v49, v49
    s_waitcnt lgkmcnt(2)
    v_smfmac_f32_32x32x32_bf16 v[64:79], v[28:31], v[40:47], v0
    s_mov_b64 exec, s[64:65]
    ds_read_b128 v[24:27], v2 offset:0
    ds_read_b128 v[28:31], v2 offset:256
    s_mov_b64 exec, -1
    v_exp_f32 v50, v50
    v_exp_f32 v51, v51
    v_exp_f32 v52, v52
    s_waitcnt lgkmcnt(2)
    v_mfma_f32_32x32x16_bf16 v[32:47], v[20:23], v[16:19], 0
    ds_read_b128 v[20:23], v1 offset:4096
    v_exp_f32 v53, v53
    v_exp_f32 v54, v54
    v_exp_f32 v55, v55
    v_exp_f32 v56, v56
    v_exp_f32 v57, v57
    s_waitcnt lgkmcnt(2)
    v_smfmac_f32_32x32x32_bf16 v[64:79], v[24:27], v[48:55], v0
    v_exp_f32 v58, v58
    v_exp_f32 v59, v59
    v_exp_f32 v60, v60
    v_exp_f32 v61, v61
    v_mfma_f32_32x32x16_bf16 v[240:255], v[132:135], v[164:167], v[240:255]
    ds_read_b64_tr_b16 v[174:175], v5 offset:3072
    buffer_load_dwordx4 v124, s[24:27], s75 offen offset:1024 lds
    s_add_u32 s75, s75, 32768
    v_exp_f32 v62, v62
    v_exp_f32 v63, v63
    v_exp_f32 v32, v32
    v_exp_f32 v33, v33
    s_waitcnt lgkmcnt(2)
    v_smfmac_f32_32x32x32_bf16 v[64:79], v[28:31], v[56:63], v0
    s_mov_b64 exec, s[64:65]
    ds_read_b128 v[24:27], v2 offset:2048
    ds_read_b128 v[28:31], v2 offset:2304
    s_mov_b64 exec, -1
    v_exp_f32 v34, v34
    v_exp_f32 v35, v35
    v_exp_f32 v36, v36
    s_waitcnt lgkmcnt(2)
    v_mfma_f32_32x32x16_bf16 v[48:63], v[20:23], v[16:19], 0
    ds_read_b128 v[20:23], v1 offset:6144
    v_exp_f32 v37, v37
    v_exp_f32 v38, v38
    v_exp_f32 v39, v39
    v_mfma_f32_32x32x16_bf16 v[192:207], v[136:139], v[168:171], v[192:207]
    ds_read_b64_tr_b16 v[160:161], v3 offset:8192
    buffer_load_dwordx4 v[176:179], v1, s[40:43], s74 offen offset:0 sc1
    v_exp_f32 v40, v40
    v_exp_f32 v41, v41
    v_exp_f32 v42, v42
    v_exp_f32 v43, v43
    s_waitcnt lgkmcnt(2)
    v_smfmac_f32_32x32x32_bf16 v[64:79], v[24:27], v[32:39], v0
    ds_write_b32 v8, v8 offset:224
    v_exp_f32 v44, v44
    v_exp_f32 v45, v45
    v_exp_f32 v46, v46
    v_mfma_f32_32x32x16_bf16 v[224:239], v[140:143], v[168:171], v[224:239]
    ds_read_b64_tr_b16 v[162:163], v3 offset:9216
    buffer_load_dwordx4 v[180:183], v1, s[40:43], s74 offen offset:1024 sc1
    v_exp_f32 v47, v47
    v_exp_f32 v48, v48
    v_exp_f32 v49, v49
    v_smfmac_f32_32x32x32_bf16 v[64:79], v[28:31], v[40:47], v0
    s_mov_b64 exec, s[64:65]
    ds_read_b128 v[24:27], v2 offset:4096
    ds_read_b128 v[28:31], v2 offset:4352
    s_mov_b64 exec, -1
    v_exp_f32 v50, v50
    v_exp_f32 v51, v51
    v_exp_f32 v52, v52
    s_waitcnt lgkmcnt(2)
    v_mfma_f32_32x32x16_bf16 v[32:47], v[20:23], v[16:19], 0
    ds_read_b128 v[20:23], v1 offset:8192
    v_exp_f32 v53, v53
    v_exp_f32 v54, v54
    v_exp_f32 v55, v55
    v_exp_f32 v56, v56
    v_exp_f32 v57, v57
    s_waitcnt lgkmcnt(2)
    v_smfmac_f32_32x32x32_bf16 v[64:79], v[24:27], v[48:55], v0
    v_exp_f32 v58, v58
    v_exp_f32 v59, v59
    v_exp_f32 v60, v60
    v_exp_f32 v61, v61
    s_add_u32 m0, s58, 2048
    v_mfma_f32_32x32x16_bf16 v[208:223], v[136:139], v[172:175], v[208:223]
    ds_read_b64_tr_b16 v[164:165], v5 offset:8192
    buffer_load_dwordx4 v12, s[24:27], s75 offen lds
    v_exp_f32 v62, v62
    v_exp_f32 v63, v63
    s_setprio 2
    v_exp_f32 v32, v32
    v_exp_f32 v33, v33
    s_waitcnt lgkmcnt(2)
    v_smfmac_f32_32x32x32_bf16 v[64:79], v[28:31], v[56:63], v0
    s_mov_b64 exec, s[64:65]
    ds_read_b128 v[24:27], v2 offset:6144
    ds_read_b128 v[28:31], v2 offset:6400
    s_mov_b64 exec, -1
    v_exp_f32 v34, v34
    v_exp_f32 v35, v35
    v_exp_f32 v36, v36
    s_waitcnt lgkmcnt(2)
    v_mfma_f32_32x32x16_bf16 v[48:63], v[20:23], v[16:19], 0
    ds_read_b128 v[20:23], v1 offset:10240
    v_exp_f32 v37, v37
    v_exp_f32 v38, v38
    v_exp_f32 v39, v39
    v_exp_f32 v40, v40
    v_exp_f32 v41, v41
    s_waitcnt lgkmcnt(2)
    v_smfmac_f32_32x32x32_bf16 v[64:79], v[24:27], v[32:39], v0
    v_exp_f32 v42, v42
    v_exp_f32 v43, v43
    v_exp_f32 v44, v44
    v_exp_f32 v45, v45
    v_mfma_f32_32x32x16_bf16 v[240:255], v[140:143], v[172:175], v[240:255]
    ds_read_b64_tr_b16 v[166:167], v5 offset:9216
    buffer_load_dwordx4 v124, s[24:27], s75 offen offset:1024 lds
    s_add_u32 s75, s75, 32768
    v_exp_f32 v46, v46
    v_exp_f32 v47, v47
    v_exp_f32 v48, v48
    v_exp_f32 v49, v49
    s_waitcnt lgkmcnt(2)
    v_smfmac_f32_32x32x32_bf16 v[64:79], v[28:31], v[40:47], v0
    s_mov_b64 exec, s[64:65]
    ds_read_b128 v[24:27], v2 offset:8192
    ds_read_b128 v[28:31], v2 offset:8448
    s_mov_b64 exec, -1
    v_exp_f32 v50, v50
    v_exp_f32 v51, v51
    v_exp_f32 v52, v52
    s_waitcnt lgkmcnt(2)
    v_mfma_f32_32x32x16_bf16 v[32:47], v[20:23], v[16:19], 0
    ds_read_b128 v[20:23], v1 offset:12288
    v_exp_f32 v53, v53
    v_exp_f32 v54, v54
    v_exp_f32 v55, v55
    v_mfma_f32_32x32x16_bf16 v[192:207], v[144:147], v[160:163], v[192:207]
    ds_read_b64_tr_b16 v[168:169], v3 offset:10240
    buffer_load_dwordx4 v[184:187], v1, s[40:43], s74 offen offset:2048 sc1
    v_exp_f32 v56, v56
    v_exp_f32 v57, v57
    v_exp_f32 v58, v58
    v_exp_f32 v59, v59
    s_waitcnt lgkmcnt(2)
    v_smfmac_f32_32x32x32_bf16 v[64:79], v[24:27], v[48:55], v0
    ds_read_b32 v10, v9 offset:224
    v_exp_f32 v60, v60
    v_exp_f32 v61, v61
    v_exp_f32 v62, v62
    v_mfma_f32_32x32x16_bf16 v[224:239], v[148:151], v[160:163], v[224:239]
    ds_read_b64_tr_b16 v[170:171], v3 offset:11264
    buffer_load_dwordx4 v[188:191], v1, s[40:43], s74 offen offset:3072 sc1
    s_add_u32 s74, s74, 4096
    v_exp_f32 v63, v63
    v_exp_f32 v32, v32
    v_exp_f32 v33, v33
    v_smfmac_f32_32x32x32_bf16 v[64:79], v[28:31], v[56:63], v0
    s_mov_b64 exec, s[64:65]
    ds_read_b128 v[24:27], v2 offset:10240
    ds_read_b128 v[28:31], v2 offset:10496
    s_mov_b64 exec, -1
    s_waitcnt lgkmcnt(2)
    v_cmp_eq_u32 vcc, 0, v10
    s_cbranch_vccnz L_ep_s_50
L_ep_b_49:
    v_exp_f32 v34, v34
    v_exp_f32 v35, v35
    v_exp_f32 v36, v36
    v_mfma_f32_32x32x16_bf16 v[48:63], v[20:23], v[16:19], 0
    ds_read_b128 v[20:23], v1 offset:14336
    v_exp_f32 v37, v37
    v_exp_f32 v38, v38
    v_exp_f32 v39, v39
    v_exp_f32 v40, v40
    v_exp_f32 v41, v41
    s_waitcnt lgkmcnt(2)
    v_smfmac_f32_32x32x32_bf16 v[64:79], v[24:27], v[32:39], v0
    v_exp_f32 v42, v42
    v_exp_f32 v43, v43
    v_exp_f32 v44, v44
    v_exp_f32 v45, v45
    s_add_u32 m0, s58, 8192
    v_mfma_f32_32x32x16_bf16 v[208:223], v[144:147], v[164:167], v[208:223]
    ds_read_b64_tr_b16 v[172:173], v5 offset:10240
    buffer_load_dwordx4 v12, s[24:27], s75 offen lds
    v_exp_f32 v46, v46
    v_exp_f32 v47, v47
    s_setprio 1
    v_exp_f32 v48, v48
    v_exp_f32 v49, v49
    s_waitcnt lgkmcnt(2)
    v_smfmac_f32_32x32x32_bf16 v[64:79], v[28:31], v[40:47], v0
    s_mov_b64 exec, s[64:65]
    ds_read_b128 v[24:27], v2 offset:12288
    ds_read_b128 v[28:31], v2 offset:12544
    s_mov_b64 exec, -1
    v_exp_f32 v50, v50
    v_exp_f32 v51, v51
    v_exp_f32 v52, v52
    s_waitcnt lgkmcnt(2)
    v_mfma_f32_32x32x16_bf16 v[32:47], v[20:23], v[16:19], 0
    ds_read_b128 v[20:23], v1 offset:16384
    v_exp_f32 v53, v53
    v_exp_f32 v54, v54
    v_exp_f32 v55, v55
    v_mfma_f32_32x32x16_bf16 v[240:255], v[148:151], v[164:167], v[240:255]
    ds_read_b64_tr_b16 v[174:175], v5 offset:11264
    buffer_load_dwordx4 v124, s[24:27], s75 offen offset:1024 lds
    s_add_u32 s75, s75, 32768
    v_exp_f32 v56, v56
    v_exp_f32 v57, v57
    v_exp_f32 v58, v58
    v_exp_f32 v59, v59
    s_waitcnt lgkmcnt(2)
    v_smfmac_f32_32x32x32_bf16 v[64:79], v[24:27], v[48:55], v0
    v_exp_f32 v60, v60
    v_exp_f32 v61, v61
    v_exp_f32 v62, v62
    s_waitcnt vmcnt(8)
    v_mfma_f32_32x32x16_bf16 v[192:207], v[152:155], v[168:171], v[192:207]
    ds_read_b64_tr_b16 v[160:161], v3 offset:0
    buffer_load_dwordx4 v[128:131], v1, s[40:43], s74 offen offset:0 sc1
    v_exp_f32 v63, v63
    s_setprio 0
    v_exp_f32 v32, v32
    v_exp_f32 v33, v33
    v_smfmac_f32_32x32x32_bf16 v[64:79], v[28:31], v[56:63], v0
    s_mov_b64 exec, s[64:65]
    ds_read_b128 v[24:27], v2 offset:14336
    ds_read_b128 v[28:31], v2 offset:14592
    s_mov_b64 exec, -1
    v_exp_f32 v34, v34
    v_exp_f32 v35, v35
    v_exp_f32 v36, v36
    s_waitcnt lgkmcnt(2)
    v_mfma_f32_32x32x16_bf16 v[48:63], v[20:23], v[16:19], 0
    ds_read_b128 v[20:23], v1 offset:18432
    v_exp_f32 v37, v37
    v_exp_f32 v38, v38
    v_exp_f32 v39, v39
    v_exp_f32 v40, v40
    v_exp_f32 v41, v41
    s_waitcnt lgkmcnt(2)
    v_smfmac_f32_32x32x32_bf16 v[64:79], v[24:27], v[32:39], v0
    v_exp_f32 v42, v42
    v_exp_f32 v43, v43
    v_exp_f32 v44, v44
    v_exp_f32 v45, v45
    v_mfma_f32_32x32x16_bf16 v[224:239], v[156:159], v[168:171], v[224:239]
    ds_read_b64_tr_b16 v[162:163], v3 offset:1024
    buffer_load_dwordx4 v[132:135], v1, s[40:43], s74 offen offset:1024 sc1
    v_exp_f32 v46, v46
    v_exp_f32 v47, v47
    s_setprio 3
    v_exp_f32 v48, v48
    v_exp_f32 v49, v49
    s_waitcnt lgkmcnt(2)
    v_smfmac_f32_32x32x32_bf16 v[64:79], v[28:31], v[40:47], v0
    s_mov_b64 exec, s[64:65]
    ds_read_b128 v[24:27], v2 offset:16384
    ds_read_b128 v[28:31], v2 offset:16640
    s_mov_b64 exec, -1
    v_exp_f32 v50, v50
    v_exp_f32 v51, v51
    v_exp_f32 v52, v52
    s_waitcnt lgkmcnt(2)
    v_mfma_f32_32x32x16_bf16 v[32:47], v[20:23], v[16:19], 0
    ds_read_b128 v[20:23], v1 offset:20480
    v_exp_f32 v53, v53
    v_exp_f32 v54, v54
    v_exp_f32 v55, v55
    v_exp_f32 v56, v56
    v_exp_f32 v57, v57
    s_waitcnt lgkmcnt(2)
    v_smfmac_f32_32x32x32_bf16 v[64:79], v[24:27], v[48:55], v0
    v_exp_f32 v58, v58
    v_exp_f32 v59, v59
    v_exp_f32 v60, v60
    v_exp_f32 v61, v61
    s_add_u32 m0, s58, 10240
    v_mfma_f32_32x32x16_bf16 v[208:223], v[152:155], v[172:175], v[208:223]
    ds_read_b64_tr_b16 v[164:165], v5 offset:0
    buffer_load_dwordx4 v12, s[24:27], s75 offen lds
    v_exp_f32 v62, v62
    v_exp_f32 v63, v63
    v_exp_f32 v32, v32
    v_exp_f32 v33, v33
    s_waitcnt lgkmcnt(2)
    v_smfmac_f32_32x32x32_bf16 v[64:79], v[28:31], v[56:63], v0
    s_mov_b64 exec, s[64:65]
    ds_read_b128 v[24:27], v2 offset:18432
    ds_read_b128 v[28:31], v2 offset:18688
    s_mov_b64 exec, -1
    v_exp_f32 v34, v34
    v_exp_f32 v35, v35
    v_exp_f32 v36, v36
    s_waitcnt lgkmcnt(2)
    v_mfma_f32_32x32x16_bf16 v[48:63], v[20:23], v[16:19], 0
    ds_read_b128 v[20:23], v1 offset:22528
    v_exp_f32 v37, v37
    v_exp_f32 v38, v38
    v_exp_f32 v39, v39
    v_mfma_f32_32x32x16_bf16 v[240:255], v[156:159], v[172:175], v[240:255]
    ds_read_b64_tr_b16 v[166:167], v5 offset:1024
    buffer_load_dwordx4 v124, s[24:27], s75 offen offset:1024 lds
    s_lshl_b32 s75, s52, 16
    s_lshl_b32 s3, s57, 7
    s_add_u32 s75, s75, s3
    v_exp_f32 v40, v40
    v_exp_f32 v41, v41
    v_exp_f32 v42, v42
    v_exp_f32 v43, v43
    s_add_u32 m0, s58, 4096
    s_waitcnt lgkmcnt(2)
    v_smfmac_f32_32x32x32_bf16 v[64:79], v[24:27], v[32:39], v0
    buffer_load_dwordx4 v12, s[12:15], s75 offen lds
    v_exp_f32 v44, v44
    v_exp_f32 v45, v45
    v_exp_f32 v46, v46
    s_waitcnt vmcnt(9)
    v_mfma_f32_32x32x16_bf16 v[192:207], v[176:179], v[160:163], v[192:207]
    ds_read_b64_tr_b16 v[168:169], v3 offset:2048
    buffer_load_dwordx4 v[136:139], v1, s[40:43], s74 offen offset:2048 sc1
    buffer_load_dwordx4 v124, s[12:15], s75 offen offset:1024 lds
    s_add_u32 s75, s75, 16384
    v_exp_f32 v47, v47
    v_exp_f32 v48, v48
    v_exp_f32 v49, v49
    v_smfmac_f32_32x32x32_bf16 v[64:79], v[28:31], v[40:47], v0
    s_mov_b64 exec, s[64:65]
    ds_read_b128 v[24:27], v2 offset:20480
    ds_read_b128 v[28:31], v2 offset:20736
    s_mov_b64 exec, -1
    v_exp_f32 v50, v50
    v_exp_f32 v51, v51
    v_exp_f32 v52, v52
    s_waitcnt lgkmcnt(2)
    v_mfma_f32_32x32x16_bf16 v[32:47], v[20:23], v[16:19], 0
    ds_read_b128 v[20:23], v1 offset:24576
    v_exp_f32 v53, v53
    v_exp_f32 v54, v54
    v_exp_f32 v55, v55
    v_exp_f32 v56, v56
    v_exp_f32 v57, v57
    s_waitcnt lgkmcnt(2)
    v_smfmac_f32_32x32x32_bf16 v[64:79], v[24:27], v[48:55], v0
    v_exp_f32 v58, v58
    v_exp_f32 v59, v59
    v_exp_f32 v60, v60
    v_exp_f32 v61, v61
    v_mfma_f32_32x32x16_bf16 v[224:239], v[180:183], v[160:163], v[224:239]
    ds_read_b64_tr_b16 v[170:171], v3 offset:3072
    buffer_load_dwordx4 v[140:143], v1, s[40:43], s74 offen offset:3072 sc1
    s_add_u32 s74, s74, 4096
    v_exp_f32 v62, v62
    v_exp_f32 v63, v63
    s_setprio 2
    v_exp_f32 v32, v32
    v_exp_f32 v33, v33
    s_waitcnt lgkmcnt(2)
    v_smfmac_f32_32x32x32_bf16 v[64:79], v[28:31], v[56:63], v0
    s_mov_b64 exec, s[64:65]
    ds_read_b128 v[24:27], v2 offset:22528
    ds_read_b128 v[28:31], v2 offset:22784
    s_mov_b64 exec, -1
    v_exp_f32 v34, v34
    v_exp_f32 v35, v35
    v_exp_f32 v36, v36
    s_waitcnt lgkmcnt(2)
    v_mfma_f32_32x32x16_bf16 v[48:63], v[20:23], v[16:19], 0
    ds_read_b128 v[20:23], v1 offset:26624
    v_exp_f32 v37, v37
    v_exp_f32 v38, v38
    v_exp_f32 v39, v39
    v_exp_f32 v40, v40
    v_exp_f32 v41, v41
    s_waitcnt lgkmcnt(2)
    v_smfmac_f32_32x32x32_bf16 v[64:79], v[24:27], v[32:39], v0
    v_exp_f32 v42, v42
    v_exp_f32 v43, v43
    v_exp_f32 v44, v44
    v_exp_f32 v45, v45
    s_add_u32 m0, s58, 6144
    v_mfma_f32_32x32x16_bf16 v[208:223], v[176:179], v[164:167], v[208:223]
    ds_read_b64_tr_b16 v[172:173], v5 offset:2048
    buffer_load_dwordx4 v12, s[12:15], s75 offen lds
    v_exp_f32 v46, v46
    v_exp_f32 v47, v47
    v_exp_f32 v48, v48
    v_exp_f32 v49, v49
    s_waitcnt lgkmcnt(2)
    v_smfmac_f32_32x32x32_bf16 v[64:79], v[28:31], v[40:47], v0
    s_mov_b64 exec, s[64:65]
    ds_read_b128 v[24:27], v2 offset:24576
    ds_read_b128 v[28:31], v2 offset:24832
    s_mov_b64 exec, -1
    v_exp_f32 v50, v50
    v_exp_f32 v51, v51
    v_exp_f32 v52, v52
    s_waitcnt lgkmcnt(2)
    v_mfma_f32_32x32x16_bf16 v[32:47], v[20:23], v[16:19], 0
    ds_read_b128 v[20:23], v1 offset:28672
    v_exp_f32 v53, v53
    v_exp_f32 v54, v54
    v_exp_f32 v55, v55
    v_mfma_f32_32x32x16_bf16 v[240:255], v[180:183], v[164:167], v[240:255]
    ds_read_b64_tr_b16 v[174:175], v5 offset:3072
    buffer_load_dwordx4 v124, s[12:15], s75 offen offset:1024 lds
    s_add_u32 s75, s75, 16384
    v_exp_f32 v56, v56
    v_exp_f32 v57, v57
    v_exp_f32 v58, v58
    v_exp_f32 v59, v59
    s_mov_b32 m0, s58
    s_waitcnt lgkmcnt(2)
    v_smfmac_f32_32x32x32_bf16 v[64:79], v[24:27], v[48:55], v0
    buffer_load_dwordx4 v12, s[12:15], s75 offen lds
    v_exp_f32 v60, v60
    v_exp_f32 v61, v61
    v_exp_f32 v62, v62
    s_waitcnt vmcnt(11)
    v_mfma_f32_32x32x16_bf16 v[192:207], v[184:187], v[168:171], v[192:207]
    ds_read_b64_tr_b16 v[160:161], v3 offset:8192
    buffer_load_dwordx4 v124, s[12:15], s75 offen offset:1024 lds
    s_add_u32 s75, s75, 16384
    v_exp_f32 v63, v63
    v_exp_f32 v32, v32
    v_exp_f32 v33, v33
    v_smfmac_f32_32x32x32_bf16 v[64:79], v[28:31], v[56:63], v0
    s_mov_b64 exec, s[64:65]
    ds_read_b128 v[24:27], v2 offset:26624
    ds_read_b128 v[28:31], v2 offset:26880
    s_mov_b64 exec, -1
    v_exp_f32 v34, v34
    v_exp_f32 v35, v35
    v_exp_f32 v36, v36
    s_waitcnt lgkmcnt(2)
    v_mfma_f32_32x32x16_bf16 v[48:63], v[20:23], v[16:19], 0
    ds_read_b128 v[20:23], v1 offset:30720
    v_exp_f32 v37, v37
    v_exp_f32 v38, v38
    v_exp_f32 v39, v39
    v_exp_f32 v40, v40
    v_exp_f32 v41, v41
    s_waitcnt lgkmcnt(2)
    v_smfmac_f32_32x32x32_bf16 v[64:79], v[24:27], v[32:39], v0
    v_exp_f32 v42, v42
    v_exp_f32 v43, v43
    v_exp_f32 v44, v44
    v_exp_f32 v45, v45
    v_mfma_f32_32x32x16_bf16 v[224:239], v[188:191], v[168:171], v[224:239]
    ds_read_b64_tr_b16 v[162:163], v3 offset:9216
    v_exp_f32 v46, v46
    v_exp_f32 v47, v47
    s_setprio 1
    v_exp_f32 v48, v48
    v_exp_f32 v49, v49
    s_waitcnt lgkmcnt(2)
    v_smfmac_f32_32x32x32_bf16 v[64:79], v[28:31], v[40:47], v0
    s_mov_b64 exec, s[64:65]
    ds_read_b128 v[24:27], v2 offset:28672
    ds_read_b128 v[28:31], v2 offset:28928
    s_mov_b64 exec, -1
    v_exp_f32 v50, v50
    v_exp_f32 v51, v51
    v_exp_f32 v52, v52
    s_waitcnt lgkmcnt(2)
    v_mfma_f32_32x32x16_bf16 v[32:47], v[20:23], v[16:19], 0
    v_exp_f32 v53, v53
    v_exp_f32 v54, v54
    v_exp_f32 v55, v55
    s_add_u32 m0, s58, 2048
    v_mfma_f32_32x32x16_bf16 v[208:223], v[184:187], v[172:175], v[208:223]
    ds_read_b64_tr_b16 v[164:165], v5 offset:8192
    buffer_load_dwordx4 v12, s[12:15], s75 offen lds
    v_exp_f32 v56, v56
    v_exp_f32 v57, v57
    v_exp_f32 v58, v58
    v_exp_f32 v59, v59
    s_waitcnt lgkmcnt(2)
    v_smfmac_f32_32x32x32_bf16 v[64:79], v[24:27], v[48:55], v0
    v_exp_f32 v60, v60
    v_exp_f32 v61, v61
    v_exp_f32 v62, v62
    v_mfma_f32_32x32x16_bf16 v[240:255], v[188:191], v[172:175], v[240:255]
    ds_read_b64_tr_b16 v[166:167], v5 offset:9216
    buffer_load_dwordx4 v124, s[12:15], s75 offen offset:1024 lds
    v_exp_f32 v63, v63
    s_setprio 0
    v_exp_f32 v32, v32
    s_waitcnt lgkmcnt(2)
    v_smfmac_f32_32x32x32_bf16 v[64:79], v[28:31], v[56:63], v0
    s_mov_b64 exec, s[64:65]
    ds_read_b128 v[24:27], v2 offset:30720
    ds_read_b128 v[28:31], v2 offset:30976
    s_mov_b64 exec, -1
    v_exp_f32 v33, v33
    v_exp_f32 v34, v34
    v_exp_f32 v35, v35
    v_exp_f32 v36, v36
    v_exp_f32 v37, v37
    v_exp_f32 v38, v38
    v_exp_f32 v39, v39
    v_exp_f32 v40, v40
    v_exp_f32 v41, v41
    v_exp_f32 v42, v42
    s_waitcnt lgkmcnt(1)
    v_smfmac_f32_32x32x32_bf16 v[64:79], v[24:27], v[32:39], v0
    s_mov_b64 exec, 2
    buffer_atomic_add v1, off, s[40:43], s71 offset:12 sc1
    s_mov_b64 exec, -1
    v_exp_f32 v43, v43
    v_exp_f32 v44, v44
    v_exp_f32 v45, v45
    v_exp_f32 v46, v46
    v_exp_f32 v47, v47
    s_setprio 3
    s_waitcnt lgkmcnt(0)
    v_smfmac_f32_32x32x32_bf16 v[64:79], v[28:31], v[40:47], v0
    s_mul_i32 s74, s56, 294912
    s_lshl_b32 s3, s52, 13
    s_add_u32 s74, s74, s3
    s_add_u32 s74, s74, 5472256
    s_add_u32 s79, s74, 4096
    s_mov_b32 s81, 0x2b800000
    s_mov_b32 s82, 0x53800000
    s_nop 4
    v_mov_b32 v73, v72
    s_nop 1
    v_permlane32_swap_b32 v72, v73
    v_cmp_le_f32 s[98:99], s81, v72
    v_cmp_ge_f32 vcc, s82, v72
    s_nop 0
    s_and_b64 vcc, vcc, s[98:99]
    s_cmp_eq_u64 vcc, -1
    s_cbranch_scc0 L_fallback
L_fb_back:
    v_rcp_f32 v74, v72
    s_nop 0
    v_mul_f32 v74, v74, v7
    v_pk_mul_f32 v[64:65], v[64:65], v[74:75] op_sel_hi:[1,0]
    v_pk_mul_f32 v[66:67], v[66:67], v[74:75] op_sel_hi:[1,0]
    v_pk_mul_f32 v[68:69], v[68:69], v[74:75] op_sel_hi:[1,0]
    v_pk_mul_f32 v[70:71], v[70:71], v[74:75] op_sel_hi:[1,0]
    v_cvt_pk_bf16_f32 v64, v64, v65
    v_cvt_pk_bf16_f32 v65, v66, v67
    v_cvt_pk_bf16_f32 v66, v68, v69
    v_cvt_pk_bf16_f32 v67, v70, v71
    v_min_u32 v64, -2, v64
    v_min_u32 v65, -2, v65
    v_min_u32 v66, -2, v66
    v_min_u32 v67, -2, v67
    buffer_store_dwordx4 v[64:67], v1, s[40:43], s73 offen sc1
    s_setprio 0
    v_mov_b32 v11, 0
    s_mov_b64 exec, 0x3
    buffer_atomic_or v11, v13, s[40:43], s72 offen offset:12 sc0 sc1
    s_mov_b64 exec, -1
    s_waitcnt vmcnt(13)
    v_mfma_f32_32x32x16_bf16 v[192:207], v[128:131], v[160:163], v[192:207]
    ds_read_b64_tr_b16 v[168:169], v3 offset:10240
    s_waitcnt vmcnt(10)
    ds_read_b64_tr_b16 v[80:81], v3 offset:4096
    v_mfma_f32_32x32x16_bf16 v[224:239], v[132:135], v[160:163], v[224:239]
    ds_read_b64_tr_b16 v[170:171], v3 offset:11264
    ds_read_b64_tr_b16 v[82:83], v3 offset:5120
    v_mfma_f32_32x32x16_bf16 v[208:223], v[128:131], v[164:167], v[208:223]
    ds_read_b64_tr_b16 v[172:173], v5 offset:10240
    ds_read_b64_tr_b16 v[84:85], v5 offset:4096
    v_mfma_f32_32x32x16_bf16 v[240:255], v[132:135], v[164:167], v[240:255]
    ds_read_b64_tr_b16 v[174:175], v5 offset:11264
    ds_read_b64_tr_b16 v[86:87], v5 offset:5120
    s_waitcnt vmcnt(9) lgkmcnt(5)
    v_mfma_f32_32x32x16_bf16 v[192:207], v[136:139], v[168:171], v[192:207]
    s_waitcnt vmcnt(7)
    ds_read_b64_tr_b16 v[88:89], v3 offset:6144
    ds_read_b64_tr_b16 v[90:91], v3 offset:7168
    v_mfma_f32_32x32x16_bf16 v[224:239], v[140:143], v[168:171], v[224:239]
    ds_read_b64_tr_b16 v[92:93], v5 offset:6144
    ds_read_b64_tr_b16 v[94:95], v5 offset:7168
    s_waitcnt lgkmcnt(5)
    v_mfma_f32_32x32x16_bf16 v[208:223], v[136:139], v[172:175], v[208:223]
    s_waitcnt vmcnt(5)
    ds_read_b64_tr_b16 v[96:97], v3 offset:0
    ds_read_b64_tr_b16 v[98:99], v3 offset:1024
    v_mfma_f32_32x32x16_bf16 v[240:255], v[140:143], v[172:175], v[240:255]
    ds_read_b64_tr_b16 v[100:101], v5 offset:0
    ds_read_b64_tr_b16 v[102:103], v5 offset:1024
    s_waitcnt vmcnt(3)
    ds_read_b64_tr_b16 v[104:105], v3 offset:2048
    ds_read_b64_tr_b16 v[106:107], v3 offset:3072
    ds_read_b64_tr_b16 v[108:109], v5 offset:2048
    ds_read_b64_tr_b16 v[110:111], v5 offset:3072
    s_lshr_b32 s3, s52, 2
    s_lshl_b32 s3, s3, 16
    s_and_b32 s81, s52, 3
    s_lshl_b32 s81, s81, 13
    s_add_u32 s3, s3, s81
    v_lshrrev_b32 v0, 8, v1
    v_bfe_u32 v10, v1, 7, 1
    v_and_b32 v115, 0x70, v1
    v_lshl_add_u32 v112, v0, 11, s3
    v_lshl_add_u32 v112, v115, 1, v112
    v_mul_u32_u24 v114, 32784, v10
    v_add_u32 v112, v112, v114
    v_xor_b32 v114, 16, v112
    v_and_b32 v113, 0x30, v1
    v_lshl_add_u32 v113, v10, 6, v113
    v_lshl_add_u32 v113, v0, 10, v113
    v_and_b32 v10, 0x40, v1
    v_lshl_add_u32 v113, v10, 6, v113
    s_lshl_b32 s61, s56, 16
    s_lshl_b32 s3, s52, 13
    s_add_u32 s61, s61, s3
    s_lshl_b32 s3, s57, 7
    s_add_u32 s61, s61, s3
    s_mov_b32 s64, 0xff00ff00
    s_mov_b32 s65, s64
    s_lshl_b32 s75, s52, 8
    s_mov_b32 m0, s75
    s_waitcnt lgkmcnt(0)
    s_barrier
    s_waitcnt vmcnt(0)
    v_cmp_gt_u32 vcc, 0x80, v11
    s_nop 0
    s_and_b32 s3, vcc_lo, 0x3
    s_cbranch_scc1 L_hp4_s_52
L_hp4_b_51:
    s_setprio 3
    buffer_load_dwordx4 v[32:35], v1, s[40:43], s74 offen offset:0 sc1
    buffer_load_dwordx4 v[36:39], v1, s[40:43], s74 offen offset:2048 sc1
    buffer_load_dwordx4 v[40:43], v1, s[40:43], s79 offen offset:0 sc1
    buffer_load_dwordx4 v[44:47], v1, s[40:43], s79 offen offset:2048 sc1
    buffer_load_dwordx4 v[48:51], v1, s[40:43], s74 offen offset:1024 sc1
    buffer_load_dwordx4 v[52:55], v1, s[40:43], s74 offen offset:3072 sc1
    buffer_load_dwordx4 v[56:59], v1, s[40:43], s79 offen offset:1024 sc1
    buffer_load_dwordx4 v[60:63], v1, s[40:43], s79 offen offset:3072 sc1
    s_waitcnt vmcnt(6)
    v_max3_u32 v10, v32, v33, v34
    v_max3_u32 v11, v35, v36, v37
    v_max3_u32 v10, v10, v38, v39
    v_max_u32 v10, v10, v11
    v_cmp_eq_u32 vcc, -1, v10
    s_cbranch_vccnz L_ov_s_54
L_ov_b_53:
    v_mfma_f32_32x32x16_bf16 v[192:207], v[32:35], v[80:83], v[192:207]
    v_mfma_f32_32x32x16_bf16 v[208:223], v[32:35], v[84:87], v[208:223]
    v_mfma_f32_32x32x16_bf16 v[192:207], v[36:39], v[88:91], v[192:207]
    v_mfma_f32_32x32x16_bf16 v[208:223], v[36:39], v[92:95], v[208:223]
    s_waitcnt vmcnt(4)
    v_max3_u32 v10, v40, v41, v42
    v_max3_u32 v11, v43, v44, v45
    v_max3_u32 v10, v10, v46, v47
    v_max_u32 v10, v10, v11
    v_cmp_eq_u32 vcc, -1, v10
    s_cbranch_vccnz L_ov_s_56
L_ov_b_55:
    v_mfma_f32_32x32x16_bf16 v[192:207], v[40:43], v[96:99], v[192:207]
    v_mfma_f32_32x32x16_bf16 v[192:207], v[44:47], v[104:107], v[192:207]
    v_mfma_f32_32x32x16_bf16 v[208:223], v[40:43], v[100:103], v[208:223]
    v_mfma_f32_32x32x16_bf16 v[208:223], v[44:47], v[108:111], v[208:223]
    s_waitcnt vmcnt(2)
    v_max3_u32 v10, v48, v49, v50
    v_max3_u32 v11, v51, v52, v53
    v_max3_u32 v10, v10, v54, v55
    v_max_u32 v10, v10, v11
    v_cmp_eq_u32 vcc, -1, v10
    s_cbranch_vccnz L_ov_s_58
L_ov_b_57:
    v_mfma_f32_32x32x16_bf16 v[224:239], v[48:51], v[80:83], v[224:239]
    v_mfma_f32_32x32x16_bf16 v[240:255], v[48:51], v[84:87], v[240:255]
    s_nop 0
    ds_write_addtid_b32 v192 offset:0
    ds_write_addtid_b32 v193 offset:2048
    v_mfma_f32_32x32x16_bf16 v[224:239], v[52:55], v[88:91], v[224:239]
    ds_write_addtid_b32 v194 offset:4096
    ds_write_addtid_b32 v195 offset:6144
    ds_write_addtid_b32 v196 offset:8192
    ds_write_addtid_b32 v197 offset:10240
    ds_write_addtid_b32 v198 offset:12288
    v_mfma_f32_32x32x16_bf16 v[240:255], v[52:55], v[92:95], v[240:255]
    ds_write_addtid_b32 v199 offset:14336
    ds_write_addtid_b32 v200 offset:16384
    ds_write_addtid_b32 v201 offset:18432
    ds_write_addtid_b32 v202 offset:20480
    ds_write_addtid_b32 v203 offset:22528
    s_waitcnt vmcnt(0)
    v_max3_u32 v10, v56, v57, v58
    v_max3_u32 v11, v59, v60, v61
    v_max3_u32 v10, v10, v62, v63
    v_max_u32 v10, v10, v11
    v_cmp_eq_u32 vcc, -1, v10
    s_cbranch_vccnz L_ov_s_60
L_ov_b_59:
    v_mfma_f32_32x32x16_bf16 v[224:239], v[56:59], v[96:99], v[224:239]
    ds_write_addtid_b32 v204 offset:24576
    ds_write_addtid_b32 v205 offset:26624
    ds_write_addtid_b32 v206 offset:28672
    ds_write_addtid_b32 v207 offset:30720
    ds_write_addtid_b32 v208 offset:32768
    v_mfma_f32_32x32x16_bf16 v[224:239], v[60:63], v[104:107], v[224:239]
    ds_write_addtid_b32 v209 offset:34816
    ds_write_addtid_b32 v210 offset:36864
    ds_write_addtid_b32 v211 offset:38912
    ds_write_addtid_b32 v212 offset:40960
    ds_write_addtid_b32 v213 offset:43008
    v_mfma_f32_32x32x16_bf16 v[240:255], v[56:59], v[100:103], v[240:255]
    ds_write_addtid_b32 v214 offset:45056
    ds_write_addtid_b32 v215 offset:47104
    ds_write_addtid_b32 v216 offset:49152
    ds_write_addtid_b32 v217 offset:51200
    ds_write_addtid_b32 v218 offset:53248
    v_mfma_f32_32x32x16_bf16 v[240:255], v[60:63], v[108:111], v[240:255]
    ds_write_addtid_b32 v219 offset:55296
    ds_write_addtid_b32 v220 offset:57344
    ds_write_addtid_b32 v221 offset:59392
    ds_write_addtid_b32 v222 offset:61440
    ds_write_addtid_b32 v223 offset:63488
    s_add_u32 m0, s75, 63616
    s_nop 0
    ds_write_addtid_b32 v224 offset:1920
    ds_write_addtid_b32 v225 offset:3968
    ds_write_addtid_b32 v226 offset:6016
    ds_write_addtid_b32 v227 offset:8064
    ds_write_addtid_b32 v228 offset:10112
    ds_write_addtid_b32 v229 offset:12160
    ds_write_addtid_b32 v230 offset:14208
    ds_write_addtid_b32 v231 offset:16256
    ds_write_addtid_b32 v232 offset:18304
    ds_write_addtid_b32 v233 offset:20352
    ds_write_addtid_b32 v234 offset:22400
    ds_write_addtid_b32 v235 offset:24448
    ds_write_addtid_b32 v236 offset:26496
    ds_write_addtid_b32 v237 offset:28544
    ds_write_addtid_b32 v238 offset:30592
    ds_write_addtid_b32 v239 offset:32640
    ds_write_addtid_b32 v240 offset:34688
    ds_write_addtid_b32 v241 offset:36736
    ds_write_addtid_b32 v242 offset:38784
    ds_write_addtid_b32 v243 offset:40832
    ds_write_addtid_b32 v244 offset:42880
    ds_write_addtid_b32 v245 offset:44928
    ds_write_addtid_b32 v246 offset:46976
    ds_write_addtid_b32 v247 offset:49024
    ds_write_addtid_b32 v248 offset:51072
    ds_write_addtid_b32 v249 offset:53120
    ds_write_addtid_b32 v250 offset:55168
    ds_write_addtid_b32 v251 offset:57216
    ds_write_addtid_b32 v252 offset:59264
    ds_write_addtid_b32 v253 offset:61312
    ds_write_addtid_b32 v254 offset:63360
    ds_write_addtid_b32 v255 offset:65408
    s_waitcnt lgkmcnt(0)
    s_barrier
    ds_read_b128 v[32:35], v112 offset:0
    ds_read_b128 v[36:39], v114 offset:0
    ds_read_b128 v[40:43], v112 offset:256
    ds_read_b128 v[44:47], v114 offset:256
    ds_read_b128 v[48:51], v112 offset:512
    ds_read_b128 v[52:55], v114 offset:512
    ds_read_b128 v[56:59], v112 offset:768
    ds_read_b128 v[60:63], v114 offset:768
    ds_read_b128 v[64:67], v112 offset:1024
    ds_read_b128 v[68:71], v114 offset:1024
    ds_read_b128 v[72:75], v112 offset:1280
    ds_read_b128 v[76:79], v114 offset:1280
    ds_read_b128 v[80:83], v112 offset:1536
    ds_read_b128 v[84:87], v114 offset:1536
    ds_read_b128 v[88:91], v112 offset:1792
    ds_read_b128 v[92:95], v114 offset:1792
    s_waitcnt lgkmcnt(12)
    v_pk_add_f32 v[32:33], v[32:33], v[40:41]
    v_pk_add_f32 v[34:35], v[34:35], v[42:43]
    v_pk_add_f32 v[36:37], v[36:37], v[44:45]
    v_pk_add_f32 v[38:39], v[38:39], v[46:47]
    s_waitcnt lgkmcnt(10)
    v_pk_add_f32 v[32:33], v[32:33], v[48:49]
    v_pk_add_f32 v[34:35], v[34:35], v[50:51]
    v_pk_add_f32 v[36:37], v[36:37], v[52:53]
    v_pk_add_f32 v[38:39], v[38:39], v[54:55]
    s_waitcnt lgkmcnt(8)
    v_pk_add_f32 v[32:33], v[32:33], v[56:57]
    v_pk_add_f32 v[34:35], v[34:35], v[58:59]
    v_pk_add_f32 v[36:37], v[36:37], v[60:61]
    v_pk_add_f32 v[38:39], v[38:39], v[62:63]
    s_waitcnt lgkmcnt(6)
    v_pk_add_f32 v[32:33], v[32:33], v[64:65]
    v_pk_add_f32 v[34:35], v[34:35], v[66:67]
    v_pk_add_f32 v[36:37], v[36:37], v[68:69]
    v_pk_add_f32 v[38:39], v[38:39], v[70:71]
    s_waitcnt lgkmcnt(4)
    v_pk_add_f32 v[32:33], v[32:33], v[72:73]
    v_pk_add_f32 v[34:35], v[34:35], v[74:75]
    v_pk_add_f32 v[36:37], v[36:37], v[76:77]
    v_pk_add_f32 v[38:39], v[38:39], v[78:79]
    s_waitcnt lgkmcnt(2)
    v_pk_add_f32 v[32:33], v[32:33], v[80:81]
    v_pk_add_f32 v[34:35], v[34:35], v[82:83]
    v_pk_add_f32 v[36:37], v[36:37], v[84:85]
    v_pk_add_f32 v[38:39], v[38:39], v[86:87]
    s_waitcnt lgkmcnt(0)
    v_pk_add_f32 v[32:33], v[32:33], v[88:89]
    v_pk_add_f32 v[34:35], v[34:35], v[90:91]
    v_pk_add_f32 v[36:37], v[36:37], v[92:93]
    v_pk_add_f32 v[38:39], v[38:39], v[94:95]
    v_cvt_pk_bf16_f32 v40, v32, v33
    v_cvt_pk_bf16_f32 v41, v34, v35
    v_cvt_pk_bf16_f32 v42, v36, v37
    v_cvt_pk_bf16_f32 v43, v38, v39
    s_mov_b64 exec, s[64:65]
    v_cvt_pk_bf16_f32 v42, v32, v33
    v_cvt_pk_bf16_f32 v43, v34, v35
    v_cvt_pk_bf16_f32 v40, v36, v37
    v_cvt_pk_bf16_f32 v41, v38, v39
    s_mov_b64 exec, -1
    buffer_store_dwordx4 v[40:43], v113, s[32:35], s61 offen sc1
L_end:
    s_endpgm
L_r0:
    s_waitcnt lgkmcnt(2)
    v_mfma_f32_32x32x16_bf16 v[96:111], v[52:55], v[224:227], v[96:111]
    ds_read_b64_tr_b16 v[52:53], v77 offset:53248
    ds_read_b64_tr_b16 v[54:55], v77 offset:53760
    s_waitcnt lgkmcnt(2)
    v_mfma_f32_32x32x16_bf16 v[96:111], v[60:63], v[228:231], v[96:111]
    ds_read_b64_tr_b16 v[60:61], v77 offset:55296
    ds_read_b64_tr_b16 v[62:63], v77 offset:55808
    s_mov_b32 s98, 0x3eb8aa3b
    s_mov_b32 s99, s98
    v_mov_b32 v78, s98
    s_waitcnt lgkmcnt(2)
    v_mfma_f32_32x32x16_bf16 v[96:111], v[52:55], v[232:235], v[96:111]
    ds_read_b64_tr_b16 v[52:53], v77 offset:57344
    ds_read_b64_tr_b16 v[54:55], v77 offset:57856
    v_pk_mul_f32 v[32:33], v[32:33], v[78:79] op_sel_hi:[1,0]
    v_pk_mul_f32 v[34:35], v[34:35], v[78:79] op_sel_hi:[1,0]
    v_pk_mul_f32 v[36:37], v[36:37], v[78:79] op_sel_hi:[1,0]
    s_waitcnt lgkmcnt(2)
    v_mfma_f32_32x32x16_bf16 v[96:111], v[60:63], v[236:239], v[96:111]
    ds_read_b64_tr_b16 v[60:61], v77 offset:59392
    ds_read_b64_tr_b16 v[62:63], v77 offset:59904
    v_pk_mul_f32 v[38:39], v[38:39], v[78:79] op_sel_hi:[1,0]
    v_cvt_pk_bf16_f32 v32, v32, v33
    v_cvt_pk_bf16_f32 v33, v34, v35
    s_waitcnt lgkmcnt(2)
    v_mfma_f32_32x32x16_bf16 v[96:111], v[52:55], v[240:243], v[96:111]
    ds_read_b64_tr_b16 v[52:53], v77 offset:61440
    ds_read_b64_tr_b16 v[54:55], v77 offset:61952
    v_cvt_pk_bf16_f32 v34, v36, v37
    v_cvt_pk_bf16_f32 v35, v38, v39
    buffer_store_dwordx4 v[32:35], v1, s[40:43], s69 offen sc1
    s_add_u32 s69, s69, 131072
    s_waitcnt lgkmcnt(2)
    v_mfma_f32_32x32x16_bf16 v[96:111], v[60:63], v[244:247], v[96:111]
    ds_read_b64_tr_b16 v[60:61], v77 offset:63488
    ds_read_b64_tr_b16 v[62:63], v77 offset:64000
    v_pk_mul_f32 v[40:41], v[40:41], v[78:79] op_sel_hi:[1,0]
    v_pk_mul_f32 v[42:43], v[42:43], v[78:79] op_sel_hi:[1,0]
    v_pk_mul_f32 v[44:45], v[44:45], v[78:79] op_sel_hi:[1,0]
    s_waitcnt lgkmcnt(2)
    v_mfma_f32_32x32x16_bf16 v[96:111], v[52:55], v[248:251], v[96:111]
    v_pk_mul_f32 v[46:47], v[46:47], v[78:79] op_sel_hi:[1,0]
    v_cvt_pk_bf16_f32 v40, v40, v41
    v_cvt_pk_bf16_f32 v41, v42, v43
    s_waitcnt lgkmcnt(0)
    v_mfma_f32_32x32x16_bf16 v[96:111], v[60:63], v[252:255], v[96:111]
    v_cvt_pk_bf16_f32 v42, v44, v45
    v_cvt_pk_bf16_f32 v43, v46, v47
    buffer_store_dwordx4 v[40:43], v1, s[40:43], s69 offen sc1
    s_add_u32 s69, s69, 131072
    s_waitcnt vmcnt(4)
    s_barrier
    ds_read_b64_tr_b16 v[112:113], v4 offset:8192
    ds_read_b64_tr_b16 v[114:115], v4 offset:8448
    ds_read_b64_tr_b16 v[116:117], v4 offset:20480
    ds_read_b64_tr_b16 v[118:119], v4 offset:20736
    s_setprio 3
    s_waitcnt lgkmcnt(2)
    v_mfma_f32_32x32x16_bf16 v[80:95], v[112:115], v[128:131], 0
    ds_read_b64_tr_b16 v[120:121], v4 offset:32768
    ds_read_b64_tr_b16 v[122:123], v4 offset:33024
    s_waitcnt lgkmcnt(2)
    v_mfma_f32_32x32x16_bf16 v[80:95], v[116:119], v[132:135], v[80:95]
    ds_read_b64_tr_b16 v[112:113], v4 offset:45056
    ds_read_b64_tr_b16 v[114:115], v4 offset:45312
    v_pk_mul_f32 v[96:97], v[96:97], v[78:79] op_sel_hi:[1,0]
    v_pk_mul_f32 v[98:99], v[98:99], v[78:79] op_sel_hi:[1,0]
    v_pk_mul_f32 v[100:101], v[100:101], v[78:79] op_sel_hi:[1,0]
    s_waitcnt lgkmcnt(2)
    v_mfma_f32_32x32x16_bf16 v[80:95], v[120:123], v[136:139], v[80:95]
    ds_read_b64_tr_b16 v[116:117], v5 offset:8192
    ds_read_b64_tr_b16 v[118:119], v5 offset:8448
    v_pk_mul_f32 v[102:103], v[102:103], v[78:79] op_sel_hi:[1,0]
    v_cvt_pk_bf16_f32 v96, v96, v97
    v_cvt_pk_bf16_f32 v97, v98, v99
    s_waitcnt lgkmcnt(2)
    v_mfma_f32_32x32x16_bf16 v[80:95], v[112:115], v[140:143], v[80:95]
    ds_read_b64_tr_b16 v[120:121], v5 offset:20480
    ds_read_b64_tr_b16 v[122:123], v5 offset:20736
    v_cvt_pk_bf16_f32 v98, v100, v101
    v_cvt_pk_bf16_f32 v99, v102, v103
    s_setprio 2
    s_waitcnt lgkmcnt(2)
    v_mfma_f32_32x32x16_bf16 v[80:95], v[116:119], v[144:147], v[80:95]
    ds_read_b64_tr_b16 v[112:113], v5 offset:32768
    ds_read_b64_tr_b16 v[114:115], v5 offset:33024
    buffer_store_dwordx4 v[96:99], v1, s[40:43], s69 offen sc1
    s_add_u32 s69, s69, 131072
    v_pk_mul_f32 v[104:105], v[104:105], v[78:79] op_sel_hi:[1,0]
    v_pk_mul_f32 v[106:107], v[106:107], v[78:79] op_sel_hi:[1,0]
    v_pk_mul_f32 v[108:109], v[108:109], v[78:79] op_sel_hi:[1,0]
    v_pk_mul_f32 v[110:111], v[110:111], v[78:79] op_sel_hi:[1,0]
    s_waitcnt lgkmcnt(2)
    v_mfma_f32_32x32x16_bf16 v[80:95], v[120:123], v[148:151], v[80:95]
    ds_read_b64_tr_b16 v[116:117], v5 offset:45056
    ds_read_b64_tr_b16 v[118:119], v5 offset:45312
    v_lshrrev_b32 v10, 2, v1
    s_mov_b32 exec_hi, 0
    buffer_store_dword v126, v10, s[40:43], s68 offen sc1
    s_mov_b64 exec, -1
    s_and_b32 s68, s68, 0xfffffc00
    v_cvt_pk_bf16_f32 v104, v104, v105
    v_cvt_pk_bf16_f32 v105, v106, v107
    v_cvt_pk_bf16_f32 v106, v108, v109
    v_cvt_pk_bf16_f32 v107, v110, v111
    s_waitcnt lgkmcnt(2)
    v_mfma_f32_32x32x16_bf16 v[80:95], v[112:115], v[152:155], v[80:95]
    ds_read_b64_tr_b16 v[120:121], v4 offset:9216
    ds_read_b64_tr_b16 v[122:123], v4 offset:9472
    buffer_store_dwordx4 v[104:107], v1, s[40:43], s69 offen sc1
    s_waitcnt lgkmcnt(2)
    v_mfma_f32_32x32x16_bf16 v[80:95], v[116:119], v[156:159], v[80:95]
    ds_read_b64_tr_b16 v[112:113], v4 offset:21504
    ds_read_b64_tr_b16 v[114:115], v4 offset:21760
    s_setprio 1
    s_waitcnt lgkmcnt(2)
    v_mfma_f32_32x32x16_bf16 v[80:95], v[120:123], v[160:163], v[80:95]
    ds_read_b64_tr_b16 v[116:117], v4 offset:33792
    ds_read_b64_tr_b16 v[118:119], v4 offset:34048
    v_mov_b32 v64, 0
    s_waitcnt lgkmcnt(2)
    v_mfma_f32_32x32x16_bf16 v[80:95], v[112:115], v[164:167], v[80:95]
    ds_read_b64_tr_b16 v[120:121], v4 offset:46080
    ds_read_b64_tr_b16 v[122:123], v4 offset:46336
    v_mov_b32 v65, 0
    s_waitcnt lgkmcnt(2)
    v_mfma_f32_32x32x16_bf16 v[80:95], v[116:119], v[168:171], v[80:95]
    ds_read_b64_tr_b16 v[112:113], v5 offset:9216
    ds_read_b64_tr_b16 v[114:115], v5 offset:9472
    v_mov_b32 v66, 0
    s_waitcnt lgkmcnt(2)
    v_mfma_f32_32x32x16_bf16 v[80:95], v[120:123], v[172:175], v[80:95]
    ds_read_b64_tr_b16 v[116:117], v5 offset:21504
    ds_read_b64_tr_b16 v[118:119], v5 offset:21760
    s_setprio 0
    s_waitcnt lgkmcnt(2)
    v_mfma_f32_32x32x16_bf16 v[80:95], v[112:115], v[176:179], v[80:95]
    ds_read_b64_tr_b16 v[120:121], v5 offset:33792
    ds_read_b64_tr_b16 v[122:123], v5 offset:34048
    v_mov_b32 v67, 0
    s_waitcnt lgkmcnt(2)
    v_mfma_f32_32x32x16_bf16 v[80:95], v[116:119], v[180:183], v[80:95]
    ds_read_b64_tr_b16 v[112:113], v5 offset:46080
    ds_read_b64_tr_b16 v[114:115], v5 offset:46336
    s_add_u32 s63, s63, 8
    s_and_b32 s63, s63, 31
    s_mul_i32 s3, s63, 57344
    s_mov_b32 m0, s58
    s_add_u32 s81, s3, s65
    buffer_load_dwordx4 v12, s[20:23], s81 offen lds
    v_mov_b32 v68, 0
    s_waitcnt lgkmcnt(2)
    v_mfma_f32_32x32x16_bf16 v[80:95], v[120:123], v[184:187], v[80:95]
    s_waitcnt vmcnt(6)
    s_barrier
    ds_read_b64_tr_b16 v[116:117], v4 offset:10240
    ds_read_b64_tr_b16 v[118:119], v4 offset:10496
    v_cmp_gt_u32 vcc, 0x80, v11
    s_nop 0
    s_and_b32 s3, vcc_lo, 0xf
    s_cbranch_scc1 L_init_s_11
L_init_b_10:
    v_mov_b32 v69, 0
    s_waitcnt lgkmcnt(2)
    v_mfma_f32_32x32x16_bf16 v[80:95], v[112:115], v[188:191], v[80:95]
    ds_read_b64_tr_b16 v[120:121], v4 offset:22528
    ds_read_b64_tr_b16 v[122:123], v4 offset:22784
    s_setprio 3
    s_waitcnt lgkmcnt(2)
    v_mfma_f32_32x32x16_bf16 v[80:95], v[116:119], v[192:195], v[80:95]
    ds_read_b64_tr_b16 v[112:113], v4 offset:34816
    ds_read_b64_tr_b16 v[114:115], v4 offset:35072
    s_waitcnt vmcnt(1)
    s_mov_b64 exec, 2
    buffer_atomic_add v1, off, s[40:43], s71 offset:0 sc1
    s_mov_b64 exec, -1
    v_mov_b32 v70, 0
    s_waitcnt lgkmcnt(2)
    v_mfma_f32_32x32x16_bf16 v[80:95], v[120:123], v[196:199], v[80:95]
    ds_read_b64_tr_b16 v[116:117], v4 offset:47104
    ds_read_b64_tr_b16 v[118:119], v4 offset:47360
    v_mov_b32 v71, 0
    s_waitcnt lgkmcnt(2)
    v_mfma_f32_32x32x16_bf16 v[80:95], v[112:115], v[200:203], v[80:95]
    ds_read_b64_tr_b16 v[120:121], v5 offset:10240
    ds_read_b64_tr_b16 v[122:123], v5 offset:10496
    v_mov_b32 v72, 0
    s_waitcnt lgkmcnt(2)
    v_mfma_f32_32x32x16_bf16 v[80:95], v[116:119], v[204:207], v[80:95]
    ds_read_b64_tr_b16 v[112:113], v5 offset:22528
    ds_read_b64_tr_b16 v[114:115], v5 offset:22784
    s_setprio 2
    s_waitcnt lgkmcnt(2)
    v_mfma_f32_32x32x16_bf16 v[80:95], v[120:123], v[208:211], v[80:95]
    ds_read_b64_tr_b16 v[116:117], v5 offset:34816
    ds_read_b64_tr_b16 v[118:119], v5 offset:35072
    v_lshrrev_b32 v6, 2, v1
    v_mov_b32 v7, 0
    ds_write2st64_b32 v6, v7, v7 offset0:194 offset1:195
    s_add_u32 s63, s63, 8
    s_and_b32 s63, s63, 31
    s_mul_i32 s3, s63, 57344
    s_add_u32 m0, s58, 1024
    s_add_u32 s81, s3, s65
    buffer_load_dwordx4 v12, s[20:23], s81 offen lds
    v_mov_b32 v73, 0
    s_waitcnt lgkmcnt(3)
    v_mfma_f32_32x32x16_bf16 v[80:95], v[112:115], v[212:215], v[80:95]
    ds_read_b64_tr_b16 v[120:121], v5 offset:47104
    ds_read_b64_tr_b16 v[122:123], v5 offset:47360
    v_mov_b32 v74, 0
    s_waitcnt lgkmcnt(3)
    v_mfma_f32_32x32x16_bf16 v[80:95], v[116:119], v[216:219], v[80:95]
    ds_read_b64_tr_b16 v[112:113], v4 offset:11264
    ds_read_b64_tr_b16 v[114:115], v4 offset:11520
    v_mov_b32 v75, 0
    s_waitcnt lgkmcnt(2)
    v_mfma_f32_32x32x16_bf16 v[80:95], v[120:123], v[220:223], v[80:95]
    ds_read_b64_tr_b16 v[116:117], v4 offset:23552
    ds_read_b64_tr_b16 v[118:119], v4 offset:23808
    s_setprio 1
    s_waitcnt lgkmcnt(2)
    v_mfma_f32_32x32x16_bf16 v[80:95], v[112:115], v[224:227], v[80:95]
    ds_read_b64_tr_b16 v[120:121], v4 offset:35840
    ds_read_b64_tr_b16 v[122:123], v4 offset:36096
    v_mov_b32 v76, 0
    s_waitcnt lgkmcnt(2)
    v_mfma_f32_32x32x16_bf16 v[80:95], v[116:119], v[228:231], v[80:95]
    ds_read_b64_tr_b16 v[112:113], v4 offset:48128
    ds_read_b64_tr_b16 v[114:115], v4 offset:48384
    v_mov_b32 v77, 0
    s_waitcnt lgkmcnt(2)
    v_mfma_f32_32x32x16_bf16 v[80:95], v[120:123], v[232:235], v[80:95]
    ds_read_b64_tr_b16 v[116:117], v5 offset:11264
    ds_read_b64_tr_b16 v[118:119], v5 offset:11520
    v_mov_b32 v78, 0
    s_waitcnt lgkmcnt(2)
    v_mfma_f32_32x32x16_bf16 v[80:95], v[112:115], v[236:239], v[80:95]
    ds_read_b64_tr_b16 v[120:121], v5 offset:23552
    ds_read_b64_tr_b16 v[122:123], v5 offset:23808
    s_setprio 0
    s_waitcnt lgkmcnt(2)
    v_mfma_f32_32x32x16_bf16 v[80:95], v[116:119], v[240:243], v[80:95]
    ds_read_b64_tr_b16 v[112:113], v5 offset:35840
    ds_read_b64_tr_b16 v[114:115], v5 offset:36096
    v_mov_b32 v79, 0
    s_waitcnt lgkmcnt(2)
    v_mfma_f32_32x32x16_bf16 v[80:95], v[120:123], v[244:247], v[80:95]
    ds_read_b64_tr_b16 v[116:117], v5 offset:48128
    ds_read_b64_tr_b16 v[118:119], v5 offset:48384
    s_add_u32 s63, s63, 8
    s_and_b32 s63, s63, 31
    s_mul_i32 s3, s63, 57344
    s_add_u32 m0, s58, 2048
    s_add_u32 s81, s3, s65
    buffer_load_dwordx4 v12, s[20:23], s81 offen lds
    v_mov_b32 v0, 0xdddddddd
    s_waitcnt lgkmcnt(2)
    v_mfma_f32_32x32x16_bf16 v[80:95], v[112:115], v[248:251], v[80:95]
    s_waitcnt vmcnt(1)
    s_barrier
    ds_read_b64_tr_b16 v[120:121], v4 offset:0
    ds_read_b64_tr_b16 v[122:123], v4 offset:256
    v_mov_b32 v11, 0
    s_mov_b64 exec, 0x1
    buffer_atomic_or v11, v13, s[40:43], s71 offen offset:0 sc0 sc1
    s_mov_b64 exec, -1
    s_waitcnt lgkmcnt(2)
    v_mfma_f32_32x32x16_bf16 v[80:95], v[116:119], v[252:255], v[80:95]
    ds_read_b64_tr_b16 v[112:113], v4 offset:12288
    ds_read_b64_tr_b16 v[114:115], v4 offset:12544
    s_add_u32 s63, s63, 8
    s_and_b32 s63, s63, 31
    s_mul_i32 s3, s63, 57344
    s_add_u32 m0, s58, 3072
    s_add_u32 s81, s3, s65
    buffer_load_dwordx4 v12, s[20:23], s81 offen lds
    s_setprio 3
    s_waitcnt lgkmcnt(2)
    v_mfma_f32_32x32x16_bf16 v[96:111], v[120:123], v[128:131], 0
    ds_read_b64_tr_b16 v[116:117], v4 offset:24576
    ds_read_b64_tr_b16 v[118:119], v4 offset:24832
    s_waitcnt lgkmcnt(2)
    v_mfma_f32_32x32x16_bf16 v[96:111], v[112:115], v[132:135], v[96:111]
    ds_read_b64_tr_b16 v[120:121], v4 offset:36864
    ds_read_b64_tr_b16 v[122:123], v4 offset:37120
    s_waitcnt lgkmcnt(2)
    v_mfma_f32_32x32x16_bf16 v[96:111], v[116:119], v[136:139], v[96:111]
    ds_read_b64_tr_b16 v[112:113], v5 offset:0
    ds_read_b64_tr_b16 v[114:115], v5 offset:256
    v_mul_f32 v80, 0xbfb8aa3b, v80
    v_mul_f32 v81, 0xbfb8aa3b, v81
    v_mul_f32 v82, 0xbfb8aa3b, v82
    v_mul_f32 v83, 0xbfb8aa3b, v83
    v_exp_f32 v80, v80
    s_waitcnt lgkmcnt(2)
    v_mfma_f32_32x32x16_bf16 v[96:111], v[120:123], v[140:143], v[96:111]
    ds_read_b64_tr_b16 v[116:117], v5 offset:12288
    ds_read_b64_tr_b16 v[118:119], v5 offset:12544
    v_exp_f32 v81, v81
    v_exp_f32 v82, v82
    v_exp_f32 v83, v83
    v_mul_f32 v84, 0xbfb8aa3b, v84
    v_mul_f32 v85, 0xbfb8aa3b, v85
    s_setprio 2
    s_waitcnt lgkmcnt(2)
    v_mfma_f32_32x32x16_bf16 v[96:111], v[112:115], v[144:147], v[96:111]
    ds_read_b64_tr_b16 v[120:121], v5 offset:24576
    ds_read_b64_tr_b16 v[122:123], v5 offset:24832
    v_mul_f32 v86, 0xbfb8aa3b, v86
    v_mul_f32 v87, 0xbfb8aa3b, v87
    v_exp_f32 v84, v84
    v_exp_f32 v85, v85
    v_exp_f32 v86, v86
    s_waitcnt lgkmcnt(2)
    v_mfma_f32_32x32x16_bf16 v[96:111], v[116:119], v[148:151], v[96:111]
    ds_read_b64_tr_b16 v[112:113], v5 offset:36864
    ds_read_b64_tr_b16 v[114:115], v5 offset:37120
    v_exp_f32 v87, v87
    v_mul_f32 v88, 0xbfb8aa3b, v88
    v_mul_f32 v89, 0xbfb8aa3b, v89
    v_mul_f32 v90, 0xbfb8aa3b, v90
    s_waitcnt lgkmcnt(2)
    v_mfma_f32_32x32x16_bf16 v[96:111], v[120:123], v[152:155], v[96:111]
    ds_read_b64_tr_b16 v[116:117], v4 offset:1024
    ds_read_b64_tr_b16 v[118:119], v4 offset:1280
    s_waitcnt vmcnt(1)
    v_cmp_gt_u32 vcc, 0x80, v11
    s_nop 0
    s_and_b32 s3, vcc_lo, 0x1
    s_cbranch_scc1 L_kp0_s_13
L_kp0_b_12:
    s_mov_b32 m0, s62
    s_add_u32 s82, s54, 0
    s_and_b32 s82, s82, 7
    s_lshl_b32 s82, s82, 14
    s_add_u32 s69, s82, s70
    buffer_load_dwordx4 v1, s[40:43], s69 offen sc1 lds
    v_mul_f32 v91, 0xbfb8aa3b, v91
    v_exp_f32 v88, v88
    v_exp_f32 v89, v89
    v_exp_f32 v90, v90
    v_exp_f32 v91, v91
    s_waitcnt lgkmcnt(2)
    v_mfma_f32_32x32x16_bf16 v[96:111], v[112:115], v[156:159], v[96:111]
    ds_read_b64_tr_b16 v[120:121], v4 offset:13312
    ds_read_b64_tr_b16 v[122:123], v4 offset:13568
    buffer_load_dwordx4 v[16:19], v1, s[40:43], s79 offen sc1
    v_mul_f32 v92, 0xbfb8aa3b, v92
    v_mul_f32 v93, 0xbfb8aa3b, v93
    v_mul_f32 v94, 0xbfb8aa3b, v94
    v_mul_f32 v95, 0xbfb8aa3b, v95
    v_exp_f32 v92, v92
    s_setprio 1
    s_waitcnt lgkmcnt(2)
    v_mfma_f32_32x32x16_bf16 v[96:111], v[116:119], v[160:163], v[96:111]
    ds_read_b64_tr_b16 v[112:113], v4 offset:25600
    ds_read_b64_tr_b16 v[114:115], v4 offset:25856
    buffer_load_dwordx4 v1, s[40:43], s69 offen offset:1024 sc1 lds
    v_exp_f32 v93, v93
    v_exp_f32 v94, v94
    v_exp_f32 v95, v95
    s_branch L_join
L_r3:
    s_waitcnt lgkmcnt(2)
    v_mfma_f32_32x32x16_bf16 v[96:111], v[52:55], v[224:227], v[96:111]
    ds_read_b64_tr_b16 v[52:53], v77 offset:53248
    ds_read_b64_tr_b16 v[54:55], v77 offset:53760
    s_waitcnt lgkmcnt(2)
    v_mfma_f32_32x32x16_bf16 v[96:111], v[60:63], v[228:231], v[96:111]
    ds_read_b64_tr_b16 v[60:61], v77 offset:55296
    ds_read_b64_tr_b16 v[62:63], v77 offset:55808
    v_mul_f32 v32, 0xbfb8aa3b, v32
    v_mul_f32 v33, 0xbfb8aa3b, v33
    v_mul_f32 v34, 0xbfb8aa3b, v34
    v_mul_f32 v35, 0xbfb8aa3b, v35
    s_waitcnt lgkmcnt(2)
    v_mfma_f32_32x32x16_bf16 v[96:111], v[52:55], v[232:235], v[96:111]
    ds_read_b64_tr_b16 v[52:53], v77 offset:57344
    ds_read_b64_tr_b16 v[54:55], v77 offset:57856
    v_exp_f32 v32, v32
    v_exp_f32 v33, v33
    v_exp_f32 v34, v34
    v_exp_f32 v35, v35
    s_waitcnt lgkmcnt(2)
    v_mfma_f32_32x32x16_bf16 v[96:111], v[60:63], v[236:239], v[96:111]
    ds_read_b64_tr_b16 v[60:61], v77 offset:59392
    ds_read_b64_tr_b16 v[62:63], v77 offset:59904
    v_add_f32 v32, 1.0, v32
    v_add_f32 v33, 1.0, v33
    v_add_f32 v34, 1.0, v34
    v_add_f32 v35, 1.0, v35
    s_waitcnt lgkmcnt(2)
    v_mfma_f32_32x32x16_bf16 v[96:111], v[52:55], v[240:243], v[96:111]
    ds_read_b64_tr_b16 v[52:53], v77 offset:61440
    ds_read_b64_tr_b16 v[54:55], v77 offset:61952
    v_rcp_f32 v32, v32
    v_rcp_f32 v33, v33
    v_rcp_f32 v34, v34
    s_waitcnt lgkmcnt(2)
    v_mfma_f32_32x32x16_bf16 v[96:111], v[60:63], v[244:247], v[96:111]
    ds_read_b64_tr_b16 v[60:61], v77 offset:63488
    ds_read_b64_tr_b16 v[62:63], v77 offset:64000
    v_rcp_f32 v35, v35
    v_mul_f32 v36, 0xbfb8aa3b, v36
    v_mul_f32 v37, 0xbfb8aa3b, v37
    s_waitcnt lgkmcnt(2)
    v_mfma_f32_32x32x16_bf16 v[96:111], v[52:55], v[248:251], v[96:111]
    v_mul_f32 v38, 0xbfb8aa3b, v38
    v_mul_f32 v39, 0xbfb8aa3b, v39
    v_exp_f32 v36, v36
    s_waitcnt lgkmcnt(0)
    v_mfma_f32_32x32x16_bf16 v[96:111], v[60:63], v[252:255], v[96:111]
    v_exp_f32 v37, v37
    v_exp_f32 v38, v38
    v_exp_f32 v39, v39
    s_waitcnt vmcnt(2)
    s_barrier
    ds_read_b64_tr_b16 v[112:113], v4 offset:8192
    ds_read_b64_tr_b16 v[114:115], v4 offset:8448
    ds_read_b64_tr_b16 v[116:117], v4 offset:20480
    ds_read_b64_tr_b16 v[118:119], v4 offset:20736
    s_setprio 3
    s_waitcnt lgkmcnt(2)
    v_mfma_f32_32x32x16_bf16 v[80:95], v[112:115], v[128:131], 0
    ds_read_b64_tr_b16 v[120:121], v4 offset:32768
    ds_read_b64_tr_b16 v[122:123], v4 offset:33024
    s_waitcnt lgkmcnt(2)
    v_mfma_f32_32x32x16_bf16 v[80:95], v[116:119], v[132:135], v[80:95]
    ds_read_b64_tr_b16 v[112:113], v4 offset:45056
    ds_read_b64_tr_b16 v[114:115], v4 offset:45312
    v_add_f32 v36, 1.0, v36
    v_add_f32 v37, 1.0, v37
    v_add_f32 v38, 1.0, v38
    s_waitcnt lgkmcnt(2)
    v_mfma_f32_32x32x16_bf16 v[80:95], v[120:123], v[136:139], v[80:95]
    ds_read_b64_tr_b16 v[116:117], v5 offset:8192
    ds_read_b64_tr_b16 v[118:119], v5 offset:8448
    v_add_f32 v39, 1.0, v39
    v_rcp_f32 v36, v36
    s_waitcnt lgkmcnt(2)
    v_mfma_f32_32x32x16_bf16 v[80:95], v[112:115], v[140:143], v[80:95]
    ds_read_b64_tr_b16 v[120:121], v5 offset:20480
    ds_read_b64_tr_b16 v[122:123], v5 offset:20736
    v_rcp_f32 v37, v37
    v_rcp_f32 v38, v38
    v_rcp_f32 v39, v39
    s_setprio 2
    s_waitcnt lgkmcnt(2)
    v_mfma_f32_32x32x16_bf16 v[80:95], v[116:119], v[144:147], v[80:95]
    ds_read_b64_tr_b16 v[112:113], v5 offset:32768
    ds_read_b64_tr_b16 v[114:115], v5 offset:33024
    v_mul_f32 v40, 0xbfb8aa3b, v40
    v_mul_f32 v41, 0xbfb8aa3b, v41
    s_waitcnt lgkmcnt(2)
    v_mfma_f32_32x32x16_bf16 v[80:95], v[120:123], v[148:151], v[80:95]
    ds_read_b64_tr_b16 v[116:117], v5 offset:45056
    ds_read_b64_tr_b16 v[118:119], v5 offset:45312
    v_lshrrev_b32 v10, 2, v1
    s_mov_b32 exec_hi, 0
    buffer_store_dword v126, v10, s[40:43], s68 offen sc1
    s_mov_b64 exec, -1
    s_and_b32 s68, s68, 0xfffffc00
    v_mul_f32 v42, 0xbfb8aa3b, v42
    v_mul_f32 v43, 0xbfb8aa3b, v43
    v_exp_f32 v40, v40
    s_waitcnt lgkmcnt(2)
    v_mfma_f32_32x32x16_bf16 v[80:95], v[112:115], v[152:155], v[80:95]
    ds_read_b64_tr_b16 v[120:121], v4 offset:9216
    ds_read_b64_tr_b16 v[122:123], v4 offset:9472
    v_exp_f32 v41, v41
    v_exp_f32 v42, v42
    s_waitcnt lgkmcnt(2)
    v_mfma_f32_32x32x16_bf16 v[80:95], v[116:119], v[156:159], v[80:95]
    ds_read_b64_tr_b16 v[112:113], v4 offset:21504
    ds_read_b64_tr_b16 v[114:115], v4 offset:21760
    v_exp_f32 v43, v43
    v_add_f32 v40, 1.0, v40
    v_add_f32 v41, 1.0, v41
    s_setprio 1
    s_waitcnt lgkmcnt(2)
    v_mfma_f32_32x32x16_bf16 v[80:95], v[120:123], v[160:163], v[80:95]
    ds_read_b64_tr_b16 v[116:117], v4 offset:33792
    ds_read_b64_tr_b16 v[118:119], v4 offset:34048
    v_add_f32 v42, 1.0, v42
    v_add_f32 v43, 1.0, v43
    s_waitcnt lgkmcnt(2)
    v_mfma_f32_32x32x16_bf16 v[80:95], v[112:115], v[164:167], v[80:95]
    ds_read_b64_tr_b16 v[120:121], v4 offset:46080
    ds_read_b64_tr_b16 v[122:123], v4 offset:46336
    v_rcp_f32 v40, v40
    v_rcp_f32 v41, v41
    s_waitcnt lgkmcnt(2)
    v_mfma_f32_32x32x16_bf16 v[80:95], v[116:119], v[168:171], v[80:95]
    ds_read_b64_tr_b16 v[112:113], v5 offset:9216
    ds_read_b64_tr_b16 v[114:115], v5 offset:9472
    v_rcp_f32 v42, v42
    v_rcp_f32 v43, v43
    v_mul_f32 v44, 0xbfb8aa3b, v44
    s_waitcnt lgkmcnt(2)
    v_mfma_f32_32x32x16_bf16 v[80:95], v[120:123], v[172:175], v[80:95]
    ds_read_b64_tr_b16 v[116:117], v5 offset:21504
    ds_read_b64_tr_b16 v[118:119], v5 offset:21760
    v_mul_f32 v45, 0xbfb8aa3b, v45
    v_mul_f32 v46, 0xbfb8aa3b, v46
    s_setprio 0
    s_waitcnt lgkmcnt(2)
    v_mfma_f32_32x32x16_bf16 v[80:95], v[112:115], v[176:179], v[80:95]
    ds_read_b64_tr_b16 v[120:121], v5 offset:33792
    ds_read_b64_tr_b16 v[122:123], v5 offset:34048
    v_mul_f32 v47, 0xbfb8aa3b, v47
    v_exp_f32 v44, v44
    v_exp_f32 v45, v45
    s_waitcnt lgkmcnt(2)
    v_mfma_f32_32x32x16_bf16 v[80:95], v[116:119], v[180:183], v[80:95]
    ds_read_b64_tr_b16 v[112:113], v5 offset:46080
    ds_read_b64_tr_b16 v[114:115], v5 offset:46336
    s_add_u32 s63, s63, 8
    s_and_b32 s63, s63, 31
    s_mul_i32 s3, s63, 57344
    s_mov_b32 m0, s58
    s_add_u32 s81, s3, s65
    buffer_load_dwordx4 v12, s[20:23], s81 offen lds
    v_exp_f32 v46, v46
    v_exp_f32 v47, v47
    s_waitcnt lgkmcnt(2)
    v_mfma_f32_32x32x16_bf16 v[80:95], v[120:123], v[184:187], v[80:95]
    s_waitcnt vmcnt(2)
    s_barrier
    ds_read_b64_tr_b16 v[116:117], v4 offset:10240
    ds_read_b64_tr_b16 v[118:119], v4 offset:10496
    v_cmp_gt_u32 vcc, 0x80, v11
    s_nop 0
    s_and_b32 s3, vcc_lo, 0xf
    s_cbranch_scc1 L_init_s_15
L_init_b_14:
    v_add_f32 v44, 1.0, v44
    v_add_f32 v45, 1.0, v45
    v_add_f32 v46, 1.0, v46
    s_waitcnt lgkmcnt(2)
    v_mfma_f32_32x32x16_bf16 v[80:95], v[112:115], v[188:191], v[80:95]
    ds_read_b64_tr_b16 v[120:121], v4 offset:22528
    ds_read_b64_tr_b16 v[122:123], v4 offset:22784
    v_add_f32 v47, 1.0, v47
    v_rcp_f32 v44, v44
    s_setprio 3
    s_waitcnt lgkmcnt(2)
    v_mfma_f32_32x32x16_bf16 v[80:95], v[116:119], v[192:195], v[80:95]
    ds_read_b64_tr_b16 v[112:113], v4 offset:34816
    ds_read_b64_tr_b16 v[114:115], v4 offset:35072
    s_waitcnt vmcnt(1)
    s_mov_b64 exec, 2
    buffer_atomic_add v1, off, s[40:43], s71 offset:0 sc1
    s_mov_b64 exec, -1
    v_rcp_f32 v45, v45
    v_rcp_f32 v46, v46
    s_waitcnt lgkmcnt(2)
    v_mfma_f32_32x32x16_bf16 v[80:95], v[120:123], v[196:199], v[80:95]
    ds_read_b64_tr_b16 v[116:117], v4 offset:47104
    ds_read_b64_tr_b16 v[118:119], v4 offset:47360
    v_rcp_f32 v47, v47
    v_mul_f32 v48, 0xbfb8aa3b, v96
    v_mul_f32 v49, 0xbfb8aa3b, v97
    s_waitcnt lgkmcnt(2)
    v_mfma_f32_32x32x16_bf16 v[80:95], v[112:115], v[200:203], v[80:95]
    ds_read_b64_tr_b16 v[120:121], v5 offset:10240
    ds_read_b64_tr_b16 v[122:123], v5 offset:10496
    v_mul_f32 v50, 0xbfb8aa3b, v98
    v_mul_f32 v51, 0xbfb8aa3b, v99
    s_waitcnt lgkmcnt(2)
    v_mfma_f32_32x32x16_bf16 v[80:95], v[116:119], v[204:207], v[80:95]
    ds_read_b64_tr_b16 v[112:113], v5 offset:22528
    ds_read_b64_tr_b16 v[114:115], v5 offset:22784
    v_mul_f32 v52, 0xbfb8aa3b, v100
    v_mul_f32 v53, 0xbfb8aa3b, v101
    v_mul_f32 v54, 0xbfb8aa3b, v102
    s_setprio 2
    s_waitcnt lgkmcnt(2)
    v_mfma_f32_32x32x16_bf16 v[80:95], v[120:123], v[208:211], v[80:95]
    ds_read_b64_tr_b16 v[116:117], v5 offset:34816
    ds_read_b64_tr_b16 v[118:119], v5 offset:35072
    v_lshrrev_b32 v6, 2, v1
    v_mov_b32 v7, 0
    ds_write2st64_b32 v6, v7, v7 offset0:194 offset1:195
    s_add_u32 s63, s63, 8
    s_and_b32 s63, s63, 31
    s_mul_i32 s3, s63, 57344
    s_add_u32 m0, s58, 1024
    s_add_u32 s81, s3, s65
    buffer_load_dwordx4 v12, s[20:23], s81 offen lds
    v_mul_f32 v55, 0xbfb8aa3b, v103
    v_mul_f32 v56, 0xbfb8aa3b, v104
    s_waitcnt lgkmcnt(3)
    v_mfma_f32_32x32x16_bf16 v[80:95], v[112:115], v[212:215], v[80:95]
    ds_read_b64_tr_b16 v[120:121], v5 offset:47104
    ds_read_b64_tr_b16 v[122:123], v5 offset:47360
    v_mul_f32 v57, 0xbfb8aa3b, v105
    v_mul_f32 v58, 0xbfb8aa3b, v106
    v_mul_f32 v59, 0xbfb8aa3b, v107
    s_waitcnt lgkmcnt(3)
    v_mfma_f32_32x32x16_bf16 v[80:95], v[116:119], v[216:219], v[80:95]
    ds_read_b64_tr_b16 v[112:113], v4 offset:11264
    ds_read_b64_tr_b16 v[114:115], v4 offset:11520
    v_mul_f32 v60, 0xbfb8aa3b, v108
    v_mul_f32 v61, 0xbfb8aa3b, v109
    s_waitcnt lgkmcnt(2)
    v_mfma_f32_32x32x16_bf16 v[80:95], v[120:123], v[220:223], v[80:95]
    ds_read_b64_tr_b16 v[116:117], v4 offset:23552
    ds_read_b64_tr_b16 v[118:119], v4 offset:23808
    v_mul_f32 v62, 0xbfb8aa3b, v110
    v_mul_f32 v63, 0xbfb8aa3b, v111
    s_setprio 1
    s_waitcnt lgkmcnt(2)
    v_mfma_f32_32x32x16_bf16 v[80:95], v[112:115], v[224:227], v[80:95]
    ds_read_b64_tr_b16 v[120:121], v4 offset:35840
    ds_read_b64_tr_b16 v[122:123], v4 offset:36096
    v_mov_b32 v64, 0
    v_mov_b32 v65, 0
    v_mov_b32 v66, 0
    s_waitcnt lgkmcnt(2)
    v_mfma_f32_32x32x16_bf16 v[80:95], v[116:119], v[228:231], v[80:95]
    ds_read_b64_tr_b16 v[112:113], v4 offset:48128
    ds_read_b64_tr_b16 v[114:115], v4 offset:48384
    v_mov_b32 v67, 0
    v_mov_b32 v68, 0
    s_waitcnt lgkmcnt(2)
    v_mfma_f32_32x32x16_bf16 v[80:95], v[120:123], v[232:235], v[80:95]
    ds_read_b64_tr_b16 v[116:117], v5 offset:11264
    ds_read_b64_tr_b16 v[118:119], v5 offset:11520
    v_mov_b32 v69, 0
    v_mov_b32 v70, 0
    v_mov_b32 v71, 0
    s_waitcnt lgkmcnt(2)
    v_mfma_f32_32x32x16_bf16 v[80:95], v[112:115], v[236:239], v[80:95]
    ds_read_b64_tr_b16 v[120:121], v5 offset:23552
    ds_read_b64_tr_b16 v[122:123], v5 offset:23808
    v_mov_b32 v72, 0
    v_mov_b32 v73, 0
    s_setprio 0
    s_waitcnt lgkmcnt(2)
    v_mfma_f32_32x32x16_bf16 v[80:95], v[116:119], v[240:243], v[80:95]
    ds_read_b64_tr_b16 v[112:113], v5 offset:35840
    ds_read_b64_tr_b16 v[114:115], v5 offset:36096
    v_mov_b32 v74, 0
    v_mov_b32 v75, 0
    v_mov_b32 v76, 0
    s_waitcnt lgkmcnt(2)
    v_mfma_f32_32x32x16_bf16 v[80:95], v[120:123], v[244:247], v[80:95]
    ds_read_b64_tr_b16 v[116:117], v5 offset:48128
    ds_read_b64_tr_b16 v[118:119], v5 offset:48384
    s_add_u32 s63, s63, 8
    s_and_b32 s63, s63, 31
    s_mul_i32 s3, s63, 57344
    s_add_u32 m0, s58, 2048
    s_add_u32 s81, s3, s65
    buffer_load_dwordx4 v12, s[20:23], s81 offen lds
    v_mov_b32 v77, 0
    v_mov_b32 v78, 0
    s_waitcnt lgkmcnt(2)
    v_mfma_f32_32x32x16_bf16 v[80:95], v[112:115], v[248:251], v[80:95]
    s_waitcnt vmcnt(1)
    s_barrier
    ds_read_b64_tr_b16 v[120:121], v4 offset:0
    ds_read_b64_tr_b16 v[122:123], v4 offset:256
    v_mov_b32 v11, 0
    s_mov_b64 exec, 0x1
    buffer_atomic_or v11, v13, s[40:43], s71 offen offset:0 sc0 sc1
    s_mov_b64 exec, -1
    v_mov_b32 v79, 0
    v_mov_b32 v0, 0xdddddddd
    s_waitcnt lgkmcnt(2)
    v_mfma_f32_32x32x16_bf16 v[80:95], v[116:119], v[252:255], v[80:95]
    ds_read_b64_tr_b16 v[112:113], v4 offset:12288
    ds_read_b64_tr_b16 v[114:115], v4 offset:12544
    s_add_u32 s63, s63, 8
    s_and_b32 s63, s63, 31
    s_mul_i32 s3, s63, 57344
    s_add_u32 m0, s58, 3072
    s_add_u32 s81, s3, s65
    buffer_load_dwordx4 v12, s[20:23], s81 offen lds
    s_setprio 3
    s_waitcnt lgkmcnt(2)
    v_mfma_f32_32x32x16_bf16 v[96:111], v[120:123], v[128:131], 0
    ds_read_b64_tr_b16 v[116:117], v4 offset:24576
    ds_read_b64_tr_b16 v[118:119], v4 offset:24832
    s_waitcnt lgkmcnt(2)
    v_mfma_f32_32x32x16_bf16 v[96:111], v[112:115], v[132:135], v[96:111]
    ds_read_b64_tr_b16 v[120:121], v4 offset:36864
    ds_read_b64_tr_b16 v[122:123], v4 offset:37120
    s_waitcnt lgkmcnt(2)
    v_mfma_f32_32x32x16_bf16 v[96:111], v[116:119], v[136:139], v[96:111]
    ds_read_b64_tr_b16 v[112:113], v5 offset:0
    ds_read_b64_tr_b16 v[114:115], v5 offset:256
    v_pk_mul_f32 v[32:33], v[32:33], v[80:81]
    v_pk_mul_f32 v[34:35], v[34:35], v[82:83]
    v_pk_mul_f32 v[36:37], v[36:37], v[84:85]
    v_pk_mul_f32 v[38:39], v[38:39], v[86:87]
    s_waitcnt lgkmcnt(2)
    v_mfma_f32_32x32x16_bf16 v[96:111], v[120:123], v[140:143], v[96:111]
    ds_read_b64_tr_b16 v[116:117], v5 offset:12288
    ds_read_b64_tr_b16 v[118:119], v5 offset:12544
    v_pk_mul_f32 v[40:41], v[40:41], v[88:89]
    v_pk_mul_f32 v[42:43], v[42:43], v[90:91]
    v_pk_mul_f32 v[44:45], v[44:45], v[92:93]
    v_pk_mul_f32 v[46:47], v[46:47], v[94:95]
    s_setprio 2
    s_waitcnt lgkmcnt(2)
    v_mfma_f32_32x32x16_bf16 v[96:111], v[112:115], v[144:147], v[96:111]
    ds_read_b64_tr_b16 v[120:121], v5 offset:24576
    ds_read_b64_tr_b16 v[122:123], v5 offset:24832
    v_exp_f32 v80, v48
    v_exp_f32 v81, v49
    v_exp_f32 v82, v50
    s_waitcnt lgkmcnt(2)
    v_mfma_f32_32x32x16_bf16 v[96:111], v[116:119], v[148:151], v[96:111]
    ds_read_b64_tr_b16 v[112:113], v5 offset:36864
    ds_read_b64_tr_b16 v[114:115], v5 offset:37120
    v_exp_f32 v83, v51
    v_exp_f32 v84, v52
    v_exp_f32 v85, v53
    v_exp_f32 v86, v54
    s_waitcnt lgkmcnt(2)
    v_mfma_f32_32x32x16_bf16 v[96:111], v[120:123], v[152:155], v[96:111]
    ds_read_b64_tr_b16 v[116:117], v4 offset:1024
    ds_read_b64_tr_b16 v[118:119], v4 offset:1280
    s_waitcnt vmcnt(1)
    v_cmp_gt_u32 vcc, 0x80, v11
    s_nop 0
    s_and_b32 s3, vcc_lo, 0x1
    s_cbranch_scc1 L_kp0_s_17
L_kp0_b_16:
    s_mov_b32 m0, s62
    s_add_u32 s82, s54, 0
    s_and_b32 s82, s82, 7
    s_lshl_b32 s82, s82, 14
    s_add_u32 s69, s82, s70
    buffer_load_dwordx4 v1, s[40:43], s69 offen sc1 lds
    v_exp_f32 v87, v55
    v_exp_f32 v88, v56
    v_exp_f32 v89, v57
    s_waitcnt lgkmcnt(2)
    v_mfma_f32_32x32x16_bf16 v[96:111], v[112:115], v[156:159], v[96:111]
    ds_read_b64_tr_b16 v[120:121], v4 offset:13312
    ds_read_b64_tr_b16 v[122:123], v4 offset:13568
    buffer_load_dwordx4 v[16:19], v1, s[40:43], s79 offen sc1
    v_exp_f32 v90, v58
    v_exp_f32 v91, v59
    v_exp_f32 v92, v60
    v_exp_f32 v93, v61
    s_setprio 1
    s_waitcnt lgkmcnt(2)
    v_mfma_f32_32x32x16_bf16 v[96:111], v[116:119], v[160:163], v[96:111]
    ds_read_b64_tr_b16 v[112:113], v4 offset:25600
    ds_read_b64_tr_b16 v[114:115], v4 offset:25856
    buffer_load_dwordx4 v1, s[40:43], s69 offen offset:1024 sc1 lds
    v_exp_f32 v94, v62
    v_exp_f32 v95, v63
    s_branch L_join
L_r2:
    s_setprio 2
    s_waitcnt lgkmcnt(6)
    v_mfma_f32_32x32x16_bf16 v[32:47], v[128:131], v[48:51], 0
    ds_read_b64_tr_b16 v[48:49], v72 offset:4096
    ds_read_b64_tr_b16 v[50:51], v72 offset:4608
    s_add_u32 s63, s63, 8
    s_and_b32 s63, s63, 31
    s_mul_i32 s3, s63, s66
    s_add_u32 m0, s62, 16384
    s_add_u32 s67, s3, s64
    buffer_load_dwordx4 v75, s[8:11], s67 offen lds
    buffer_load_dwordx4 v76, s[8:11], s67 offen offset:1024 lds
    s_waitcnt lgkmcnt(4)
    v_mfma_f32_32x32x16_bf16 v[32:47], v[132:135], v[56:59], v[32:47]
    ds_read_b64_tr_b16 v[56:57], v72 offset:6144
    ds_read_b64_tr_b16 v[58:59], v72 offset:6656
    s_add_u32 s3, s55, 2
    s_and_b32 s3, s3, 7
    s_lshl_b32 s3, s3, 7
    s_add_u32 m0, s58, 8192
    s_add_u32 s83, s3, s61
    buffer_load_dwordx4 v64, s[4:7], s83 offen lds
    buffer_load_dwordx4 v65, s[4:7], s83 offen offset:1024 lds
    s_setprio 1
    s_waitcnt lgkmcnt(2)
    v_mfma_f32_32x32x16_bf16 v[32:47], v[136:139], v[48:51], v[32:47]
    ds_read_b64_tr_b16 v[48:49], v72 offset:8192
    ds_read_b64_tr_b16 v[50:51], v72 offset:8704
    s_waitcnt vmcnt(10)
    ds_read_b128 v[80:83], v74 offset:0
    ds_read_b128 v[84:87], v74 offset:32
    ds_read_b128 v[88:91], v74 offset:64
    ds_read_b128 v[92:95], v74 offset:96
    buffer_load_dwordx4 v66, s[4:7], s83 offen offset:2048 lds
    s_waitcnt lgkmcnt(6)
    v_mfma_f32_32x32x16_bf16 v[32:47], v[140:143], v[56:59], v[32:47]
    s_waitcnt vmcnt(7)
    ds_read_b128 v[144:147], v68 offset:4096
    ds_read_b128 v[148:151], v69 offset:4096
    ds_read_b128 v[152:155], v70 offset:4096
    ds_read_b128 v[156:159], v71 offset:4096
    ds_read_b64_tr_b16 v[56:57], v72 offset:10240
    ds_read_b64_tr_b16 v[58:59], v72 offset:10752
    buffer_load_dwordx4 v67, s[4:7], s83 offen offset:3072 lds
    s_waitcnt lgkmcnt(6)
    s_cmp_eq_u32 s50, 0
    s_cbranch_scc0 L_dot_18
    v_dot2_f32_bf16 v112, v128, v80, 0
    v_dot2_f32_bf16 v113, v129, v81, 0
    v_dot2_f32_bf16 v114, v130, v82, 0
    v_dot2_f32_bf16 v115, v131, v83, 0
    v_dot2_f32_bf16 v112, v132, v84, v112
    v_dot2_f32_bf16 v113, v133, v85, v113
    v_dot2_f32_bf16 v114, v134, v86, v114
    v_dot2_f32_bf16 v115, v135, v87, v115
    v_dot2_f32_bf16 v112, v136, v88, v112
    v_dot2_f32_bf16 v113, v137, v89, v113
    v_dot2_f32_bf16 v114, v138, v90, v114
    v_dot2_f32_bf16 v115, v139, v91, v115
    v_dot2_f32_bf16 v112, v140, v92, v112
    v_dot2_f32_bf16 v113, v141, v93, v113
    v_dot2_f32_bf16 v114, v142, v94, v114
    v_dot2_f32_bf16 v115, v143, v95, v115
L_dot_18:
    s_setprio 0
    s_waitcnt lgkmcnt(5)
    v_mfma_f32_32x32x16_bf16 v[32:47], v[144:147], v[48:51], v[32:47]
    ds_read_b64_tr_b16 v[48:49], v72 offset:12288
    ds_read_b64_tr_b16 v[50:51], v72 offset:12800
    s_cmp_eq_u32 s48, 0
    s_cbranch_scc1 L_ldst_19
L_ldst_19_b:
    s_add_u32 s3, s55, 3
    s_and_b32 s3, s3, 7
    s_lshl_b32 s3, s3, 7
    s_mov_b32 m0, s58
    s_add_u32 s83, s3, s61
    buffer_load_dwordx4 v64, s[4:7], s83 offen lds
    s_waitcnt lgkmcnt(2)
    v_mfma_f32_32x32x16_bf16 v[32:47], v[148:151], v[56:59], v[32:47]
    ds_read_b64_tr_b16 v[56:57], v72 offset:14336
    ds_read_b64_tr_b16 v[58:59], v72 offset:14848
    buffer_load_dwordx4 v65, s[4:7], s83 offen offset:1024 lds
    s_setprio 3
    s_waitcnt lgkmcnt(2)
    v_mfma_f32_32x32x16_bf16 v[32:47], v[152:155], v[48:51], v[32:47]
    s_waitcnt vmcnt(6)
    s_barrier
    ds_read_b64_tr_b16 v[48:49], v72 offset:16384
    ds_read_b64_tr_b16 v[50:51], v72 offset:16896
    buffer_load_dwordx4 v66, s[4:7], s83 offen offset:2048 lds
    buffer_load_dwordx4 v67, s[4:7], s83 offen offset:3072 lds
    s_waitcnt lgkmcnt(2)
    v_mfma_f32_32x32x16_bf16 v[32:47], v[156:159], v[56:59], v[32:47]
    s_waitcnt vmcnt(4)
    ds_read_b128 v[160:163], v68 offset:8192
    ds_read_b128 v[164:167], v69 offset:8192
    ds_read_b128 v[168:171], v70 offset:8192
    ds_read_b128 v[172:175], v71 offset:8192
    ds_read_b64_tr_b16 v[56:57], v72 offset:18432
    ds_read_b64_tr_b16 v[58:59], v72 offset:18944
    s_cmp_eq_u32 s50, 1
    s_cbranch_scc0 L_dot_20
    v_dot2_f32_bf16 v112, v144, v80, 0
    v_dot2_f32_bf16 v113, v145, v81, 0
    v_dot2_f32_bf16 v114, v146, v82, 0
    v_dot2_f32_bf16 v115, v147, v83, 0
    v_dot2_f32_bf16 v112, v148, v84, v112
    v_dot2_f32_bf16 v113, v149, v85, v113
    v_dot2_f32_bf16 v114, v150, v86, v114
    v_dot2_f32_bf16 v115, v151, v87, v115
    v_dot2_f32_bf16 v112, v152, v88, v112
    v_dot2_f32_bf16 v113, v153, v89, v113
    v_dot2_f32_bf16 v114, v154, v90, v114
    v_dot2_f32_bf16 v115, v155, v91, v115
    v_dot2_f32_bf16 v112, v156, v92, v112
    v_dot2_f32_bf16 v113, v157, v93, v113
    v_dot2_f32_bf16 v114, v158, v94, v114
    v_dot2_f32_bf16 v115, v159, v95, v115
L_dot_20:
    s_add_u32 s63, s63, 8
    s_and_b32 s63, s63, 31
    s_mul_i32 s3, s63, s66
    s_add_u32 m0, s62, 32768
    s_add_u32 s67, s3, s64
    buffer_load_dwordx4 v75, s[8:11], s67 offen lds
    s_setprio 2
    s_waitcnt lgkmcnt(5)
    v_mfma_f32_32x32x16_bf16 v[32:47], v[160:163], v[48:51], v[32:47]
    ds_read_b64_tr_b16 v[48:49], v72 offset:20480
    ds_read_b64_tr_b16 v[50:51], v72 offset:20992
    buffer_load_dwordx4 v76, s[8:11], s67 offen offset:1024 lds
    s_waitcnt lgkmcnt(2)
    v_mfma_f32_32x32x16_bf16 v[32:47], v[164:167], v[56:59], v[32:47]
    ds_read_b64_tr_b16 v[56:57], v72 offset:22528
    ds_read_b64_tr_b16 v[58:59], v72 offset:23040
    s_add_u32 s3, s55, 4
    s_and_b32 s3, s3, 7
    s_lshl_b32 s3, s3, 7
    s_add_u32 m0, s58, 4096
    s_add_u32 s83, s3, s61
    buffer_load_dwordx4 v64, s[4:7], s83 offen lds
    buffer_load_dwordx4 v65, s[4:7], s83 offen offset:1024 lds
    s_setprio 1
    s_waitcnt lgkmcnt(2)
    v_mfma_f32_32x32x16_bf16 v[32:47], v[168:171], v[48:51], v[32:47]
    ds_read_b64_tr_b16 v[48:49], v72 offset:24576
    ds_read_b64_tr_b16 v[50:51], v72 offset:25088
    buffer_load_dwordx4 v66, s[4:7], s83 offen offset:2048 lds
    s_waitcnt lgkmcnt(2)
    v_mfma_f32_32x32x16_bf16 v[32:47], v[172:175], v[56:59], v[32:47]
    s_waitcnt vmcnt(5)
    ds_read_b128 v[176:179], v68 offset:0
    ds_read_b128 v[180:183], v69 offset:0
    ds_read_b128 v[184:187], v70 offset:0
    ds_read_b128 v[188:191], v71 offset:0
    ds_read_b64_tr_b16 v[56:57], v72 offset:26624
    ds_read_b64_tr_b16 v[58:59], v72 offset:27136
    buffer_load_dwordx4 v67, s[4:7], s83 offen offset:3072 lds
    s_cmp_eq_u32 s50, 2
    s_cbranch_scc0 L_dot_21
    v_dot2_f32_bf16 v112, v160, v80, 0
    v_dot2_f32_bf16 v113, v161, v81, 0
    v_dot2_f32_bf16 v114, v162, v82, 0
    v_dot2_f32_bf16 v115, v163, v83, 0
    v_dot2_f32_bf16 v112, v164, v84, v112
    v_dot2_f32_bf16 v113, v165, v85, v113
    v_dot2_f32_bf16 v114, v166, v86, v114
    v_dot2_f32_bf16 v115, v167, v87, v115
    v_dot2_f32_bf16 v112, v168, v88, v112
    v_dot2_f32_bf16 v113, v169, v89, v113
    v_dot2_f32_bf16 v114, v170, v90, v114
    v_dot2_f32_bf16 v115, v171, v91, v115
    v_dot2_f32_bf16 v112, v172, v92, v112
    v_dot2_f32_bf16 v113, v173, v93, v113
    v_dot2_f32_bf16 v114, v174, v94, v114
    v_dot2_f32_bf16 v115, v175, v95, v115
L_dot_21:
    s_setprio 0
    s_waitcnt lgkmcnt(5)
    v_mfma_f32_32x32x16_bf16 v[32:47], v[176:179], v[48:51], v[32:47]
    ds_read_b64_tr_b16 v[48:49], v72 offset:28672
    ds_read_b64_tr_b16 v[50:51], v72 offset:29184
    s_add_u32 s3, s55, 5
    s_and_b32 s3, s3, 7
    s_lshl_b32 s3, s3, 7
    s_add_u32 m0, s58, 8192
    s_add_u32 s83, s3, s61
    buffer_load_dwordx4 v64, s[4:7], s83 offen lds
    v_mfma_f32_32x32x16_bf16 v[96:111], v[128:131], v[52:55], 0
    ds_read_b64_tr_b16 v[52:53], v77 offset:4096
    ds_read_b64_tr_b16 v[54:55], v77 offset:4608
    buffer_load_dwordx4 v65, s[4:7], s83 offen offset:1024 lds
    s_waitcnt lgkmcnt(4)
    v_mfma_f32_32x32x16_bf16 v[32:47], v[180:183], v[56:59], v[32:47]
    ds_read_b64_tr_b16 v[56:57], v72 offset:30720
    ds_read_b64_tr_b16 v[58:59], v72 offset:31232
    v_mfma_f32_32x32x16_bf16 v[96:111], v[132:135], v[60:63], v[96:111]
    ds_read_b64_tr_b16 v[60:61], v77 offset:6144
    ds_read_b64_tr_b16 v[62:63], v77 offset:6656
    buffer_load_dwordx4 v66, s[4:7], s83 offen offset:2048 lds
    s_setprio 3
    s_waitcnt lgkmcnt(6)
    v_mfma_f32_32x32x16_bf16 v[32:47], v[184:187], v[48:51], v[32:47]
    s_waitcnt vmcnt(7)
    s_barrier
    ds_read_b64_tr_b16 v[48:49], v72 offset:32768
    ds_read_b64_tr_b16 v[50:51], v72 offset:33280
    s_waitcnt lgkmcnt(6)
    v_mfma_f32_32x32x16_bf16 v[96:111], v[136:139], v[52:55], v[96:111]
    ds_read_b64_tr_b16 v[52:53], v77 offset:8192
    ds_read_b64_tr_b16 v[54:55], v77 offset:8704
    buffer_load_dwordx4 v67, s[4:7], s83 offen offset:3072 lds
    s_waitcnt lgkmcnt(6)
    v_mfma_f32_32x32x16_bf16 v[32:47], v[188:191], v[56:59], v[32:47]
    s_waitcnt vmcnt(4)
    ds_read_b128 v[192:195], v68 offset:4096
    ds_read_b128 v[196:199], v69 offset:4096
    ds_read_b128 v[200:203], v70 offset:4096
    ds_read_b128 v[204:207], v71 offset:4096
    ds_read_b64_tr_b16 v[56:57], v72 offset:34816
    ds_read_b64_tr_b16 v[58:59], v72 offset:35328
    s_add_u32 s63, s63, 8
    s_and_b32 s63, s63, 31
    s_mul_i32 s3, s63, s66
    s_add_u32 m0, s62, 49152
    s_add_u32 s67, s3, s64
    buffer_load_dwordx4 v75, s[8:11], s67 offen lds
    s_cmp_eq_u32 s50, 3
    s_cbranch_scc0 L_dot_22
    v_dot2_f32_bf16 v112, v176, v80, 0
    v_dot2_f32_bf16 v113, v177, v81, 0
    v_dot2_f32_bf16 v114, v178, v82, 0
    v_dot2_f32_bf16 v115, v179, v83, 0
    v_dot2_f32_bf16 v112, v180, v84, v112
    v_dot2_f32_bf16 v113, v181, v85, v113
    v_dot2_f32_bf16 v114, v182, v86, v114
    v_dot2_f32_bf16 v115, v183, v87, v115
    v_dot2_f32_bf16 v112, v184, v88, v112
    v_dot2_f32_bf16 v113, v185, v89, v113
    v_dot2_f32_bf16 v114, v186, v90, v114
    v_dot2_f32_bf16 v115, v187, v91, v115
    v_dot2_f32_bf16 v112, v188, v92, v112
    v_dot2_f32_bf16 v113, v189, v93, v113
    v_dot2_f32_bf16 v114, v190, v94, v114
    v_dot2_f32_bf16 v115, v191, v95, v115
L_dot_22:
    s_waitcnt lgkmcnt(10)
    v_mfma_f32_32x32x16_bf16 v[96:111], v[140:143], v[60:63], v[96:111]
    ds_read_b64_tr_b16 v[60:61], v77 offset:10240
    ds_read_b64_tr_b16 v[62:63], v77 offset:10752
    s_setprio 2
    s_waitcnt lgkmcnt(7)
    v_mfma_f32_32x32x16_bf16 v[32:47], v[192:195], v[48:51], v[32:47]
    ds_read_b64_tr_b16 v[48:49], v72 offset:36864
    ds_read_b64_tr_b16 v[50:51], v72 offset:37376
    buffer_load_dwordx4 v76, s[8:11], s67 offen offset:1024 lds
    v_mfma_f32_32x32x16_bf16 v[96:111], v[144:147], v[52:55], v[96:111]
    ds_read_b64_tr_b16 v[52:53], v77 offset:12288
    ds_read_b64_tr_b16 v[54:55], v77 offset:12800
    s_waitcnt lgkmcnt(4)
    v_mfma_f32_32x32x16_bf16 v[96:111], v[148:151], v[60:63], v[96:111]
    ds_read_b64_tr_b16 v[60:61], v77 offset:14336
    ds_read_b64_tr_b16 v[62:63], v77 offset:14848
    s_add_u32 s3, s55, 6
    s_and_b32 s3, s3, 7
    s_lshl_b32 s3, s3, 7
    s_mov_b32 m0, s58
    s_add_u32 s83, s3, s61
    buffer_load_dwordx4 v64, s[4:7], s83 offen lds
    v_mfma_f32_32x32x16_bf16 v[32:47], v[196:199], v[56:59], v[32:47]
    ds_read_b64_tr_b16 v[56:57], v72 offset:38912
    ds_read_b64_tr_b16 v[58:59], v72 offset:39424
    v_add_f32 v112, v112, v113
    v_add_f32 v114, v114, v115
    v_add_f32 v126, v112, v114
    v_mov_b32 v127, v126
    s_nop 1
    v_permlane32_swap_b32 v126, v127
    v_add_f32 v126, v126, v127
    s_waitcnt lgkmcnt(4)
    v_mfma_f32_32x32x16_bf16 v[96:111], v[152:155], v[52:55], v[96:111]
    ds_read_b64_tr_b16 v[52:53], v77 offset:16384
    ds_read_b64_tr_b16 v[54:55], v77 offset:16896
    buffer_load_dwordx4 v65, s[4:7], s83 offen offset:1024 lds
    s_setprio 1
    v_mfma_f32_32x32x16_bf16 v[32:47], v[200:203], v[48:51], v[32:47]
    ds_read_b64_tr_b16 v[48:49], v72 offset:40960
    ds_read_b64_tr_b16 v[50:51], v72 offset:41472
    s_waitcnt lgkmcnt(6)
    v_mfma_f32_32x32x16_bf16 v[96:111], v[156:159], v[60:63], v[96:111]
    ds_read_b64_tr_b16 v[60:61], v77 offset:18432
    ds_read_b64_tr_b16 v[62:63], v77 offset:18944
    buffer_load_dwordx4 v66, s[4:7], s83 offen offset:2048 lds
    s_waitcnt lgkmcnt(6)
    v_mfma_f32_32x32x16_bf16 v[32:47], v[204:207], v[56:59], v[32:47]
    s_waitcnt vmcnt(5)
    ds_read_b128 v[208:211], v68 offset:8192
    ds_read_b128 v[212:215], v69 offset:8192
    ds_read_b128 v[216:219], v70 offset:8192
    ds_read_b128 v[220:223], v71 offset:8192
    ds_read_b64_tr_b16 v[56:57], v72 offset:43008
    ds_read_b64_tr_b16 v[58:59], v72 offset:43520
    buffer_load_dwordx4 v67, s[4:7], s83 offen offset:3072 lds
    s_waitcnt lgkmcnt(10)
    v_mfma_f32_32x32x16_bf16 v[96:111], v[160:163], v[52:55], v[96:111]
    ds_read_b64_tr_b16 v[52:53], v77 offset:20480
    ds_read_b64_tr_b16 v[54:55], v77 offset:20992
    s_setprio 0
    s_waitcnt lgkmcnt(7)
    v_mfma_f32_32x32x16_bf16 v[32:47], v[208:211], v[48:51], v[32:47]
    ds_read_b64_tr_b16 v[48:49], v72 offset:45056
    ds_read_b64_tr_b16 v[50:51], v72 offset:45568
    v_mfma_f32_32x32x16_bf16 v[96:111], v[164:167], v[60:63], v[96:111]
    ds_read_b64_tr_b16 v[60:61], v77 offset:22528
    ds_read_b64_tr_b16 v[62:63], v77 offset:23040
    s_add_u32 s3, s55, 7
    s_and_b32 s3, s3, 7
    s_lshl_b32 s3, s3, 7
    s_add_u32 m0, s58, 4096
    s_add_u32 s83, s3, s61
    buffer_load_dwordx4 v64, s[4:7], s83 offen lds
    s_waitcnt lgkmcnt(6)
    v_mfma_f32_32x32x16_bf16 v[32:47], v[212:215], v[56:59], v[32:47]
    ds_read_b64_tr_b16 v[56:57], v72 offset:47104
    ds_read_b64_tr_b16 v[58:59], v72 offset:47616
    s_waitcnt lgkmcnt(6)
    v_mfma_f32_32x32x16_bf16 v[96:111], v[168:171], v[52:55], v[96:111]
    ds_read_b64_tr_b16 v[52:53], v77 offset:24576
    ds_read_b64_tr_b16 v[54:55], v77 offset:25088
    s_waitcnt lgkmcnt(4)
    v_mfma_f32_32x32x16_bf16 v[96:111], v[172:175], v[60:63], v[96:111]
    ds_read_b64_tr_b16 v[60:61], v77 offset:26624
    ds_read_b64_tr_b16 v[62:63], v77 offset:27136
    buffer_load_dwordx4 v65, s[4:7], s83 offen offset:1024 lds
    s_setprio 3
    v_mfma_f32_32x32x16_bf16 v[32:47], v[216:219], v[48:51], v[32:47]
    s_waitcnt vmcnt(6)
    s_barrier
    ds_read_b64_tr_b16 v[48:49], v72 offset:49152
    ds_read_b64_tr_b16 v[50:51], v72 offset:49664
    s_waitcnt lgkmcnt(4)
    v_mfma_f32_32x32x16_bf16 v[96:111], v[176:179], v[52:55], v[96:111]
    ds_read_b64_tr_b16 v[52:53], v77 offset:28672
    ds_read_b64_tr_b16 v[54:55], v77 offset:29184
    buffer_load_dwordx4 v66, s[4:7], s83 offen offset:2048 lds
    v_mfma_f32_32x32x16_bf16 v[32:47], v[220:223], v[56:59], v[32:47]
    s_waitcnt vmcnt(3)
    ds_read_b128 v[224:227], v68 offset:0
    ds_read_b128 v[228:231], v69 offset:0
    ds_read_b128 v[232:235], v70 offset:0
    ds_read_b128 v[236:239], v71 offset:0
    ds_read_b64_tr_b16 v[56:57], v72 offset:51200
    ds_read_b64_tr_b16 v[58:59], v72 offset:51712
    s_waitcnt lgkmcnt(10)
    v_mfma_f32_32x32x16_bf16 v[96:111], v[180:183], v[60:63], v[96:111]
    ds_read_b64_tr_b16 v[60:61], v77 offset:30720
    ds_read_b64_tr_b16 v[62:63], v77 offset:31232
    buffer_load_dwordx4 v67, s[4:7], s83 offen offset:3072 lds
    s_setprio 2
    s_waitcnt lgkmcnt(7)
    v_mfma_f32_32x32x16_bf16 v[32:47], v[224:227], v[48:51], v[32:47]
    ds_read_b64_tr_b16 v[48:49], v72 offset:53248
    ds_read_b64_tr_b16 v[50:51], v72 offset:53760
    v_mfma_f32_32x32x16_bf16 v[96:111], v[184:187], v[52:55], v[96:111]
    ds_read_b64_tr_b16 v[52:53], v77 offset:32768
    ds_read_b64_tr_b16 v[54:55], v77 offset:33280
    v_lshrrev_b32 v11, 2, v1
    s_mov_b64 exec, 0xf
    buffer_load_dword v11, v11, s[36:39], 0 offen sc1
    s_mov_b64 exec, -1
    s_waitcnt lgkmcnt(6)
    v_mfma_f32_32x32x16_bf16 v[32:47], v[228:231], v[56:59], v[32:47]
    ds_read_b64_tr_b16 v[56:57], v72 offset:55296
    ds_read_b64_tr_b16 v[58:59], v72 offset:55808
    s_waitcnt lgkmcnt(6)
    v_mfma_f32_32x32x16_bf16 v[96:111], v[188:191], v[60:63], v[96:111]
    ds_read_b64_tr_b16 v[60:61], v77 offset:34816
    ds_read_b64_tr_b16 v[62:63], v77 offset:35328
    s_add_u32 s63, s63, 8
    s_and_b32 s63, s63, 31
    s_mul_i32 s3, s63, 57344
    s_add_u32 m0, s58, 8192
    s_add_u32 s81, s3, s76
    buffer_load_dwordx4 v12, s[44:47], s81 offen lds
    s_setprio 1
    s_waitcnt lgkmcnt(6)
    v_mfma_f32_32x32x16_bf16 v[32:47], v[232:235], v[48:51], v[32:47]
    ds_read_b64_tr_b16 v[48:49], v72 offset:57344
    ds_read_b64_tr_b16 v[50:51], v72 offset:57856
    s_waitcnt lgkmcnt(6)
    v_mfma_f32_32x32x16_bf16 v[96:111], v[192:195], v[52:55], v[96:111]
    ds_read_b64_tr_b16 v[52:53], v77 offset:36864
    ds_read_b64_tr_b16 v[54:55], v77 offset:37376
    s_waitcnt lgkmcnt(4)
    v_mfma_f32_32x32x16_bf16 v[96:111], v[196:199], v[60:63], v[96:111]
    ds_read_b64_tr_b16 v[60:61], v77 offset:38912
    ds_read_b64_tr_b16 v[62:63], v77 offset:39424
    s_add_u32 s63, s63, 8
    s_and_b32 s63, s63, 31
    s_mul_i32 s3, s63, 57344
    s_add_u32 m0, s58, 9216
    s_add_u32 s81, s3, s76
    buffer_load_dwordx4 v12, s[44:47], s81 offen lds
    v_mfma_f32_32x32x16_bf16 v[32:47], v[236:239], v[56:59], v[32:47]
    s_waitcnt vmcnt(3)
    ds_read_b128 v[240:243], v68 offset:4096
    ds_read_b128 v[244:247], v69 offset:4096
    ds_read_b128 v[248:251], v70 offset:4096
    ds_read_b128 v[252:255], v71 offset:4096
    ds_read_b64_tr_b16 v[56:57], v72 offset:59392
    ds_read_b64_tr_b16 v[58:59], v72 offset:59904
    s_waitcnt lgkmcnt(8)
    v_mfma_f32_32x32x16_bf16 v[96:111], v[200:203], v[52:55], v[96:111]
    ds_read_b64_tr_b16 v[52:53], v77 offset:40960
    ds_read_b64_tr_b16 v[54:55], v77 offset:41472
    s_add_u32 s63, s63, 8
    s_and_b32 s63, s63, 31
    s_mul_i32 s3, s63, 57344
    s_add_u32 m0, s58, 10240
    s_add_u32 s81, s3, s76
    buffer_load_dwordx4 v12, s[44:47], s81 offen lds
    s_setprio 0
    s_waitcnt lgkmcnt(7)
    v_mfma_f32_32x32x16_bf16 v[32:47], v[240:243], v[48:51], v[32:47]
    ds_read_b64_tr_b16 v[48:49], v72 offset:61440
    ds_read_b64_tr_b16 v[50:51], v72 offset:61952
    v_mfma_f32_32x32x16_bf16 v[96:111], v[204:207], v[60:63], v[96:111]
    ds_read_b64_tr_b16 v[60:61], v77 offset:43008
    ds_read_b64_tr_b16 v[62:63], v77 offset:43520
    s_waitcnt lgkmcnt(6)
    v_mfma_f32_32x32x16_bf16 v[32:47], v[244:247], v[56:59], v[32:47]
    ds_read_b64_tr_b16 v[56:57], v72 offset:63488
    ds_read_b64_tr_b16 v[58:59], v72 offset:64000
    s_waitcnt lgkmcnt(6)
    v_mfma_f32_32x32x16_bf16 v[96:111], v[208:211], v[52:55], v[96:111]
    ds_read_b64_tr_b16 v[52:53], v77 offset:45056
    ds_read_b64_tr_b16 v[54:55], v77 offset:45568
    s_setprio 3
    s_waitcnt lgkmcnt(6)
    v_mfma_f32_32x32x16_bf16 v[32:47], v[248:251], v[48:51], v[32:47]
    s_waitcnt lgkmcnt(4)
    v_mfma_f32_32x32x16_bf16 v[96:111], v[212:215], v[60:63], v[96:111]
    ds_read_b64_tr_b16 v[60:61], v77 offset:47104
    ds_read_b64_tr_b16 v[62:63], v77 offset:47616
    s_add_u32 s63, s63, 8
    s_and_b32 s63, s63, 31
    s_mul_i32 s3, s63, 57344
    s_add_u32 m0, s58, 11264
    s_add_u32 s81, s3, s76
    buffer_load_dwordx4 v12, s[44:47], s81 offen lds
    s_waitcnt lgkmcnt(4)
    v_mfma_f32_32x32x16_bf16 v[32:47], v[252:255], v[56:59], v[32:47]
    s_waitcnt lgkmcnt(2)
    v_mfma_f32_32x32x16_bf16 v[96:111], v[216:219], v[52:55], v[96:111]
    ds_read_b64_tr_b16 v[52:53], v77 offset:49152
    ds_read_b64_tr_b16 v[54:55], v77 offset:49664
    s_waitcnt lgkmcnt(2)
    v_mfma_f32_32x32x16_bf16 v[96:111], v[220:223], v[60:63], v[96:111]
    ds_read_b64_tr_b16 v[60:61], v77 offset:51200
    ds_read_b64_tr_b16 v[62:63], v77 offset:51712
    s_waitcnt lgkmcnt(2)
    v_mfma_f32_32x32x16_bf16 v[96:111], v[224:227], v[52:55], v[96:111]
    ds_read_b64_tr_b16 v[52:53], v77 offset:53248
    ds_read_b64_tr_b16 v[54:55], v77 offset:53760
    s_waitcnt lgkmcnt(2)
    v_mfma_f32_32x32x16_bf16 v[96:111], v[228:231], v[60:63], v[96:111]
    ds_read_b64_tr_b16 v[60:61], v77 offset:55296
    ds_read_b64_tr_b16 v[62:63], v77 offset:55808
    v_and_b32 v78, 0x2f0, v1
    v_bfe_u32 v79, v1, 8, 1
    v_lshl_add_u32 v78, v79, 17, v78
    s_waitcnt lgkmcnt(2)
    v_mfma_f32_32x32x16_bf16 v[96:111], v[232:235], v[52:55], v[96:111]
    ds_read_b64_tr_b16 v[52:53], v77 offset:57344
    ds_read_b64_tr_b16 v[54:55], v77 offset:57856
    v_cvt_pk_bf16_f32 v32, v32, v33
    v_cvt_pk_bf16_f32 v33, v34, v35
    v_cvt_pk_bf16_f32 v34, v36, v37
    s_waitcnt lgkmcnt(2)
    v_mfma_f32_32x32x16_bf16 v[96:111], v[236:239], v[60:63], v[96:111]
    ds_read_b64_tr_b16 v[60:61], v77 offset:59392
    ds_read_b64_tr_b16 v[62:63], v77 offset:59904
    v_cvt_pk_bf16_f32 v35, v38, v39
    v_permlane32_swap_b32 v32, v34
    s_nop 0
    v_permlane32_swap_b32 v33, v35
    s_waitcnt lgkmcnt(2)
    v_mfma_f32_32x32x16_bf16 v[96:111], v[240:243], v[52:55], v[96:111]
    ds_read_b64_tr_b16 v[52:53], v77 offset:61440
    ds_read_b64_tr_b16 v[54:55], v77 offset:61952
    buffer_store_dwordx4 v[32:35], v78, s[40:43], s69 offen offset:1024 sc1
    v_cvt_pk_bf16_f32 v40, v40, v41
    s_waitcnt lgkmcnt(2)
    v_mfma_f32_32x32x16_bf16 v[96:111], v[244:247], v[60:63], v[96:111]
    ds_read_b64_tr_b16 v[60:61], v77 offset:63488
    ds_read_b64_tr_b16 v[62:63], v77 offset:64000
    v_cvt_pk_bf16_f32 v41, v42, v43
    v_cvt_pk_bf16_f32 v42, v44, v45
    s_waitcnt lgkmcnt(2)
    v_mfma_f32_32x32x16_bf16 v[96:111], v[248:251], v[52:55], v[96:111]
    v_cvt_pk_bf16_f32 v43, v46, v47
    v_permlane32_swap_b32 v40, v42
    s_waitcnt lgkmcnt(0)
    v_mfma_f32_32x32x16_bf16 v[96:111], v[252:255], v[60:63], v[96:111]
    v_permlane32_swap_b32 v41, v43
    buffer_store_dwordx4 v[40:43], v78, s[40:43], s69 offen offset:1280 sc1
    s_add_u32 s69, s69, 262144
    s_waitcnt vmcnt(4)
    s_barrier
    ds_read_b64_tr_b16 v[112:113], v4 offset:8192
    ds_read_b64_tr_b16 v[114:115], v4 offset:8448
    ds_read_b64_tr_b16 v[116:117], v4 offset:20480
    ds_read_b64_tr_b16 v[118:119], v4 offset:20736
    s_setprio 3
    s_waitcnt lgkmcnt(2)
    v_mfma_f32_32x32x16_bf16 v[80:95], v[112:115], v[128:131], 0
    ds_read_b64_tr_b16 v[120:121], v4 offset:32768
    ds_read_b64_tr_b16 v[122:123], v4 offset:33024
    s_waitcnt lgkmcnt(2)
    v_mfma_f32_32x32x16_bf16 v[80:95], v[116:119], v[132:135], v[80:95]
    ds_read_b64_tr_b16 v[112:113], v4 offset:45056
    ds_read_b64_tr_b16 v[114:115], v4 offset:45312
    v_cvt_pk_bf16_f32 v96, v96, v97
    v_cvt_pk_bf16_f32 v97, v98, v99
    s_waitcnt lgkmcnt(2)
    v_mfma_f32_32x32x16_bf16 v[80:95], v[120:123], v[136:139], v[80:95]
    ds_read_b64_tr_b16 v[116:117], v5 offset:8192
    ds_read_b64_tr_b16 v[118:119], v5 offset:8448
    v_cvt_pk_bf16_f32 v98, v100, v101
    v_cvt_pk_bf16_f32 v99, v102, v103
    s_waitcnt lgkmcnt(2)
    v_mfma_f32_32x32x16_bf16 v[80:95], v[112:115], v[140:143], v[80:95]
    ds_read_b64_tr_b16 v[120:121], v5 offset:20480
    ds_read_b64_tr_b16 v[122:123], v5 offset:20736
    v_permlane32_swap_b32 v96, v98
    v_permlane32_swap_b32 v97, v99
    s_setprio 2
    s_waitcnt lgkmcnt(2)
    v_mfma_f32_32x32x16_bf16 v[80:95], v[116:119], v[144:147], v[80:95]
    ds_read_b64_tr_b16 v[112:113], v5 offset:32768
    ds_read_b64_tr_b16 v[114:115], v5 offset:33024
    buffer_store_dwordx4 v[96:99], v78, s[40:43], s69 offen offset:1024 sc1
    v_cvt_pk_bf16_f32 v104, v104, v105
    v_cvt_pk_bf16_f32 v105, v106, v107
    v_cvt_pk_bf16_f32 v106, v108, v109
    s_waitcnt lgkmcnt(2)
    v_mfma_f32_32x32x16_bf16 v[80:95], v[120:123], v[148:151], v[80:95]
    ds_read_b64_tr_b16 v[116:117], v5 offset:45056
    ds_read_b64_tr_b16 v[118:119], v5 offset:45312
    v_lshrrev_b32 v10, 2, v1
    s_mov_b32 exec_hi, 0
    buffer_store_dword v126, v10, s[40:43], s68 offen sc1
    s_mov_b64 exec, -1
    s_and_b32 s68, s68, 0xfffffc00
    v_cvt_pk_bf16_f32 v107, v110, v111
    v_permlane32_swap_b32 v104, v106
    s_nop 0
    v_permlane32_swap_b32 v105, v107
    s_waitcnt lgkmcnt(2)
    v_mfma_f32_32x32x16_bf16 v[80:95], v[112:115], v[152:155], v[80:95]
    ds_read_b64_tr_b16 v[120:121], v4 offset:9216
    ds_read_b64_tr_b16 v[122:123], v4 offset:9472
    buffer_store_dwordx4 v[104:107], v78, s[40:43], s69 offen offset:1280 sc1
    s_waitcnt lgkmcnt(2)
    v_mfma_f32_32x32x16_bf16 v[80:95], v[116:119], v[156:159], v[80:95]
    ds_read_b64_tr_b16 v[112:113], v4 offset:21504
    ds_read_b64_tr_b16 v[114:115], v4 offset:21760
    s_setprio 1
    s_waitcnt lgkmcnt(2)
    v_mfma_f32_32x32x16_bf16 v[80:95], v[120:123], v[160:163], v[80:95]
    ds_read_b64_tr_b16 v[116:117], v4 offset:33792
    ds_read_b64_tr_b16 v[118:119], v4 offset:34048
    v_mov_b32 v64, 0
    s_waitcnt lgkmcnt(2)
    v_mfma_f32_32x32x16_bf16 v[80:95], v[112:115], v[164:167], v[80:95]
    ds_read_b64_tr_b16 v[120:121], v4 offset:46080
    ds_read_b64_tr_b16 v[122:123], v4 offset:46336
    v_mov_b32 v65, 0
    s_waitcnt lgkmcnt(2)
    v_mfma_f32_32x32x16_bf16 v[80:95], v[116:119], v[168:171], v[80:95]
    ds_read_b64_tr_b16 v[112:113], v5 offset:9216
    ds_read_b64_tr_b16 v[114:115], v5 offset:9472
    v_mov_b32 v66, 0
    s_waitcnt lgkmcnt(2)
    v_mfma_f32_32x32x16_bf16 v[80:95], v[120:123], v[172:175], v[80:95]
    ds_read_b64_tr_b16 v[116:117], v5 offset:21504
    ds_read_b64_tr_b16 v[118:119], v5 offset:21760
    s_setprio 0
    s_waitcnt lgkmcnt(2)
    v_mfma_f32_32x32x16_bf16 v[80:95], v[112:115], v[176:179], v[80:95]
    ds_read_b64_tr_b16 v[120:121], v5 offset:33792
    ds_read_b64_tr_b16 v[122:123], v5 offset:34048
    v_mov_b32 v67, 0
    s_waitcnt lgkmcnt(2)
    v_mfma_f32_32x32x16_bf16 v[80:95], v[116:119], v[180:183], v[80:95]
    ds_read_b64_tr_b16 v[112:113], v5 offset:46080
    ds_read_b64_tr_b16 v[114:115], v5 offset:46336
    s_add_u32 s63, s63, 8
    s_and_b32 s63, s63, 31
    s_mul_i32 s3, s63, 57344
    s_mov_b32 m0, s58
    s_add_u32 s81, s3, s65
    buffer_load_dwordx4 v12, s[20:23], s81 offen lds
    v_mov_b32 v68, 0
    s_waitcnt lgkmcnt(2)
    v_mfma_f32_32x32x16_bf16 v[80:95], v[120:123], v[184:187], v[80:95]
    s_waitcnt vmcnt(6)
    s_barrier
    ds_read_b64_tr_b16 v[116:117], v4 offset:10240
    ds_read_b64_tr_b16 v[118:119], v4 offset:10496
    v_cmp_gt_u32 vcc, 0x80, v11
    s_nop 0
    s_and_b32 s3, vcc_lo, 0xf
    s_cbranch_scc1 L_init_s_24
L_init_b_23:
    v_mov_b32 v69, 0
    s_waitcnt lgkmcnt(2)
    v_mfma_f32_32x32x16_bf16 v[80:95], v[112:115], v[188:191], v[80:95]
    ds_read_b64_tr_b16 v[120:121], v4 offset:22528
    ds_read_b64_tr_b16 v[122:123], v4 offset:22784
    s_setprio 3
    s_waitcnt lgkmcnt(2)
    v_mfma_f32_32x32x16_bf16 v[80:95], v[116:119], v[192:195], v[80:95]
    ds_read_b64_tr_b16 v[112:113], v4 offset:34816
    ds_read_b64_tr_b16 v[114:115], v4 offset:35072
    s_waitcnt vmcnt(1)
    s_mov_b64 exec, 2
    buffer_atomic_add v1, off, s[40:43], s71 offset:0 sc1
    s_mov_b64 exec, -1
    v_mov_b32 v70, 0
    s_waitcnt lgkmcnt(2)
    v_mfma_f32_32x32x16_bf16 v[80:95], v[120:123], v[196:199], v[80:95]
    ds_read_b64_tr_b16 v[116:117], v4 offset:47104
    ds_read_b64_tr_b16 v[118:119], v4 offset:47360
    v_mov_b32 v71, 0
    s_waitcnt lgkmcnt(2)
    v_mfma_f32_32x32x16_bf16 v[80:95], v[112:115], v[200:203], v[80:95]
    ds_read_b64_tr_b16 v[120:121], v5 offset:10240
    ds_read_b64_tr_b16 v[122:123], v5 offset:10496
    v_mov_b32 v72, 0
    s_waitcnt lgkmcnt(2)
    v_mfma_f32_32x32x16_bf16 v[80:95], v[116:119], v[204:207], v[80:95]
    ds_read_b64_tr_b16 v[112:113], v5 offset:22528
    ds_read_b64_tr_b16 v[114:115], v5 offset:22784
    s_setprio 2
    s_waitcnt lgkmcnt(2)
    v_mfma_f32_32x32x16_bf16 v[80:95], v[120:123], v[208:211], v[80:95]
    ds_read_b64_tr_b16 v[116:117], v5 offset:34816
    ds_read_b64_tr_b16 v[118:119], v5 offset:35072
    v_lshrrev_b32 v6, 2, v1
    v_mov_b32 v7, 0
    ds_write2st64_b32 v6, v7, v7 offset0:194 offset1:195
    s_add_u32 s63, s63, 8
    s_and_b32 s63, s63, 31
    s_mul_i32 s3, s63, 57344
    s_add_u32 m0, s58, 1024
    s_add_u32 s81, s3, s65
    buffer_load_dwordx4 v12, s[20:23], s81 offen lds
    v_mov_b32 v73, 0
    s_waitcnt lgkmcnt(3)
    v_mfma_f32_32x32x16_bf16 v[80:95], v[112:115], v[212:215], v[80:95]
    ds_read_b64_tr_b16 v[120:121], v5 offset:47104
    ds_read_b64_tr_b16 v[122:123], v5 offset:47360
    v_mov_b32 v74, 0
    s_waitcnt lgkmcnt(3)
    v_mfma_f32_32x32x16_bf16 v[80:95], v[116:119], v[216:219], v[80:95]
    ds_read_b64_tr_b16 v[112:113], v4 offset:11264
    ds_read_b64_tr_b16 v[114:115], v4 offset:11520
    v_mov_b32 v75, 0
    s_waitcnt lgkmcnt(2)
    v_mfma_f32_32x32x16_bf16 v[80:95], v[120:123], v[220:223], v[80:95]
    ds_read_b64_tr_b16 v[116:117], v4 offset:23552
    ds_read_b64_tr_b16 v[118:119], v4 offset:23808
    s_setprio 1
    s_waitcnt lgkmcnt(2)
    v_mfma_f32_32x32x16_bf16 v[80:95], v[112:115], v[224:227], v[80:95]
    ds_read_b64_tr_b16 v[120:121], v4 offset:35840
    ds_read_b64_tr_b16 v[122:123], v4 offset:36096
    v_mov_b32 v76, 0
    s_waitcnt lgkmcnt(2)
    v_mfma_f32_32x32x16_bf16 v[80:95], v[116:119], v[228:231], v[80:95]
    ds_read_b64_tr_b16 v[112:113], v4 offset:48128
    ds_read_b64_tr_b16 v[114:115], v4 offset:48384
    v_mov_b32 v77, 0
    s_waitcnt lgkmcnt(2)
    v_mfma_f32_32x32x16_bf16 v[80:95], v[120:123], v[232:235], v[80:95]
    ds_read_b64_tr_b16 v[116:117], v5 offset:11264
    ds_read_b64_tr_b16 v[118:119], v5 offset:11520
    v_mov_b32 v78, 0
    s_waitcnt lgkmcnt(2)
    v_mfma_f32_32x32x16_bf16 v[80:95], v[112:115], v[236:239], v[80:95]
    ds_read_b64_tr_b16 v[120:121], v5 offset:23552
    ds_read_b64_tr_b16 v[122:123], v5 offset:23808
    s_setprio 0
    s_waitcnt lgkmcnt(2)
    v_mfma_f32_32x32x16_bf16 v[80:95], v[116:119], v[240:243], v[80:95]
    ds_read_b64_tr_b16 v[112:113], v5 offset:35840
    ds_read_b64_tr_b16 v[114:115], v5 offset:36096
    v_mov_b32 v79, 0
    s_waitcnt lgkmcnt(2)
    v_mfma_f32_32x32x16_bf16 v[80:95], v[120:123], v[244:247], v[80:95]
    ds_read_b64_tr_b16 v[116:117], v5 offset:48128
    ds_read_b64_tr_b16 v[118:119], v5 offset:48384
    s_add_u32 s63, s63, 8
    s_and_b32 s63, s63, 31
    s_mul_i32 s3, s63, 57344
    s_add_u32 m0, s58, 2048
    s_add_u32 s81, s3, s65
    buffer_load_dwordx4 v12, s[20:23], s81 offen lds
    v_mov_b32 v0, 0xdddddddd
    s_waitcnt lgkmcnt(2)
    v_mfma_f32_32x32x16_bf16 v[80:95], v[112:115], v[248:251], v[80:95]
    s_waitcnt vmcnt(1)
    s_barrier
    ds_read_b64_tr_b16 v[120:121], v4 offset:0
    ds_read_b64_tr_b16 v[122:123], v4 offset:256
    v_mov_b32 v11, 0
    s_mov_b64 exec, 0x1
    buffer_atomic_or v11, v13, s[40:43], s71 offen offset:0 sc0 sc1
    s_mov_b64 exec, -1
    s_waitcnt lgkmcnt(2)
    v_mfma_f32_32x32x16_bf16 v[80:95], v[116:119], v[252:255], v[80:95]
    ds_read_b64_tr_b16 v[112:113], v4 offset:12288
    ds_read_b64_tr_b16 v[114:115], v4 offset:12544
    s_add_u32 s63, s63, 8
    s_and_b32 s63, s63, 31
    s_mul_i32 s3, s63, 57344
    s_add_u32 m0, s58, 3072
    s_add_u32 s81, s3, s65
    buffer_load_dwordx4 v12, s[20:23], s81 offen lds
    s_setprio 3
    s_waitcnt lgkmcnt(2)
    v_mfma_f32_32x32x16_bf16 v[96:111], v[120:123], v[128:131], 0
    ds_read_b64_tr_b16 v[116:117], v4 offset:24576
    ds_read_b64_tr_b16 v[118:119], v4 offset:24832
    s_waitcnt lgkmcnt(2)
    v_mfma_f32_32x32x16_bf16 v[96:111], v[112:115], v[132:135], v[96:111]
    ds_read_b64_tr_b16 v[120:121], v4 offset:36864
    ds_read_b64_tr_b16 v[122:123], v4 offset:37120
    s_waitcnt lgkmcnt(2)
    v_mfma_f32_32x32x16_bf16 v[96:111], v[116:119], v[136:139], v[96:111]
    ds_read_b64_tr_b16 v[112:113], v5 offset:0
    ds_read_b64_tr_b16 v[114:115], v5 offset:256
    v_mul_f32 v80, 0xbfb8aa3b, v80
    v_mul_f32 v81, 0xbfb8aa3b, v81
    v_mul_f32 v82, 0xbfb8aa3b, v82
    v_mul_f32 v83, 0xbfb8aa3b, v83
    v_exp_f32 v80, v80
    s_waitcnt lgkmcnt(2)
    v_mfma_f32_32x32x16_bf16 v[96:111], v[120:123], v[140:143], v[96:111]
    ds_read_b64_tr_b16 v[116:117], v5 offset:12288
    ds_read_b64_tr_b16 v[118:119], v5 offset:12544
    v_exp_f32 v81, v81
    v_exp_f32 v82, v82
    v_exp_f32 v83, v83
    v_mul_f32 v84, 0xbfb8aa3b, v84
    v_mul_f32 v85, 0xbfb8aa3b, v85
    s_setprio 2
    s_waitcnt lgkmcnt(2)
    v_mfma_f32_32x32x16_bf16 v[96:111], v[112:115], v[144:147], v[96:111]
    ds_read_b64_tr_b16 v[120:121], v5 offset:24576
    ds_read_b64_tr_b16 v[122:123], v5 offset:24832
    v_mul_f32 v86, 0xbfb8aa3b, v86
    v_mul_f32 v87, 0xbfb8aa3b, v87
    v_exp_f32 v84, v84
    v_exp_f32 v85, v85
    v_exp_f32 v86, v86
    s_waitcnt lgkmcnt(2)
    v_mfma_f32_32x32x16_bf16 v[96:111], v[116:119], v[148:151], v[96:111]
    ds_read_b64_tr_b16 v[112:113], v5 offset:36864
    ds_read_b64_tr_b16 v[114:115], v5 offset:37120
    v_exp_f32 v87, v87
    v_mul_f32 v88, 0xbfb8aa3b, v88
    v_mul_f32 v89, 0xbfb8aa3b, v89
    v_mul_f32 v90, 0xbfb8aa3b, v90
    s_waitcnt lgkmcnt(2)
    v_mfma_f32_32x32x16_bf16 v[96:111], v[120:123], v[152:155], v[96:111]
    ds_read_b64_tr_b16 v[116:117], v4 offset:1024
    ds_read_b64_tr_b16 v[118:119], v4 offset:1280
    s_waitcnt vmcnt(1)
    v_cmp_gt_u32 vcc, 0x80, v11
    s_nop 0
    s_and_b32 s3, vcc_lo, 0x1
    s_cbranch_scc1 L_kp0_s_26
L_kp0_b_25:
    s_mov_b32 m0, s62
    s_add_u32 s82, s54, 0
    s_and_b32 s82, s82, 7
    s_lshl_b32 s82, s82, 14
    s_add_u32 s69, s82, s70
    buffer_load_dwordx4 v1, s[40:43], s69 offen sc1 lds
    v_mul_f32 v91, 0xbfb8aa3b, v91
    v_exp_f32 v88, v88
    v_exp_f32 v89, v89
    v_exp_f32 v90, v90
    v_exp_f32 v91, v91
    s_waitcnt lgkmcnt(2)
    v_mfma_f32_32x32x16_bf16 v[96:111], v[112:115], v[156:159], v[96:111]
    ds_read_b64_tr_b16 v[120:121], v4 offset:13312
    ds_read_b64_tr_b16 v[122:123], v4 offset:13568
    buffer_load_dwordx4 v[16:19], v1, s[40:43], s79 offen sc1
    v_mul_f32 v92, 0xbfb8aa3b, v92
    v_mul_f32 v93, 0xbfb8aa3b, v93
    v_mul_f32 v94, 0xbfb8aa3b, v94
    v_mul_f32 v95, 0xbfb8aa3b, v95
    v_exp_f32 v92, v92
    s_setprio 1
    s_waitcnt lgkmcnt(2)
    v_mfma_f32_32x32x16_bf16 v[96:111], v[116:119], v[160:163], v[96:111]
    ds_read_b64_tr_b16 v[112:113], v4 offset:25600
    ds_read_b64_tr_b16 v[114:115], v4 offset:25856
    buffer_load_dwordx4 v1, s[40:43], s69 offen offset:1024 sc1 lds
    v_exp_f32 v93, v93
    v_exp_f32 v94, v94
    v_exp_f32 v95, v95
    s_branch L_join

L_lead:
    v_mov_b32 v112, 0
    v_mov_b32 v113, 0
    v_mov_b32 v114, 0
    v_mov_b32 v115, 0
    v_lshlrev_b32 v11, 10, v0
    s_mov_b32 s42, 33554432
    s_mov_b32 s43, s7
    s_lshl_b32 s3, s2, 16
    buffer_store_dwordx4 v[112:115], v11, s[40:43], s3 offen sc1
    s_branch L_lead_b
L_ldst_2:
    v_mov_b32 v10, 0x80
    s_lshl_b32 s3, s2, 2
    s_mov_b64 exec, 1
    buffer_store_dword v10, off, s[36:39], s3 sc1
    s_mov_b64 exec, -1
    s_branch L_ldst_2_b
L_ldst_19:
    v_mov_b32 v10, 0x80
    s_lshl_b32 s3, s2, 2
    s_mov_b64 exec, 1
    buffer_store_dword v10, off, s[36:39], s3 sc1
    s_mov_b64 exec, -1
    s_branch L_ldst_19_b
L_hp4_s_52:
    s_mov_b32 s83, 200000
L_hp4_s_52_l:
    v_mov_b32 v11, 0
    s_mov_b64 exec, 0x3
    buffer_atomic_or v11, v13, s[40:43], s72 offen offset:12 sc0 sc1
    s_mov_b64 exec, -1
    s_waitcnt vmcnt(0)
    v_cmp_gt_u32 vcc, 0x80, v11
    s_nop 1
    s_and_b32 s3, vcc_lo, 0x3
    s_cbranch_scc0 L_hp4_b_51
    s_sub_u32 s83, s83, 1
    s_cmp_lg_u32 s83, 0
    s_cbranch_scc1 L_hp4_s_52_l
    s_branch L_hp4_b_51
L_kp0_s_9:
    s_mov_b32 s83, 200000
L_kp0_s_9_l:
    v_mov_b32 v11, 0
    s_mov_b64 exec, 0x1
    buffer_atomic_or v11, v13, s[40:43], s71 offen offset:0 sc0 sc1
    s_mov_b64 exec, -1
    s_waitcnt vmcnt(0)
    v_cmp_gt_u32 vcc, 0x80, v11
    s_nop 1
    s_and_b32 s3, vcc_lo, 0x1
    s_cbranch_scc0 L_kp0_b_8
    s_sub_u32 s83, s83, 1
    s_cmp_lg_u32 s83, 0
    s_cbranch_scc1 L_kp0_s_9_l
    s_branch L_kp0_b_8
L_kp0_s_13:
    s_mov_b32 s83, 200000
L_kp0_s_13_l:
    v_mov_b32 v11, 0
    s_mov_b64 exec, 0x1
    buffer_atomic_or v11, v13, s[40:43], s71 offen offset:0 sc0 sc1
    s_mov_b64 exec, -1
    s_waitcnt vmcnt(0)
    v_cmp_gt_u32 vcc, 0x80, v11
    s_nop 1
    s_and_b32 s3, vcc_lo, 0x1
    s_cbranch_scc0 L_kp0_b_12
    s_sub_u32 s83, s83, 1
    s_cmp_lg_u32 s83, 0
    s_cbranch_scc1 L_kp0_s_13_l
    s_branch L_kp0_b_12
L_kp0_s_17:
    s_mov_b32 s83, 200000
L_kp0_s_17_l:
    v_mov_b32 v11, 0
    s_mov_b64 exec, 0x1
    buffer_atomic_or v11, v13, s[40:43], s71 offen offset:0 sc0 sc1
    s_mov_b64 exec, -1
    s_waitcnt vmcnt(0)
    v_cmp_gt_u32 vcc, 0x80, v11
    s_nop 1
    s_and_b32 s3, vcc_lo, 0x1
    s_cbranch_scc0 L_kp0_b_16
    s_sub_u32 s83, s83, 1
    s_cmp_lg_u32 s83, 0
    s_cbranch_scc1 L_kp0_s_17_l
    s_branch L_kp0_b_16
L_kp0_s_26:
    s_mov_b32 s83, 200000
L_kp0_s_26_l:
    v_mov_b32 v11, 0
    s_mov_b64 exec, 0x1
    buffer_atomic_or v11, v13, s[40:43], s71 offen offset:0 sc0 sc1
    s_mov_b64 exec, -1
    s_waitcnt vmcnt(0)
    v_cmp_gt_u32 vcc, 0x80, v11
    s_nop 1
    s_and_b32 s3, vcc_lo, 0x1
    s_cbranch_scc0 L_kp0_b_25
    s_sub_u32 s83, s83, 1
    s_cmp_lg_u32 s83, 0
    s_cbranch_scc1 L_kp0_s_26_l
    s_branch L_kp0_b_25
L_kp1_s_28:
    s_mov_b32 s83, 200000
L_kp1_s_28_l:
    s_add_u32 s82, s71, 0x8000
    s_and_b32 s82, s82, 0x3ffff
    v_mov_b32 v11, 0
    s_mov_b64 exec, 0x1
    buffer_atomic_or v11, v13, s[40:43], s82 offen offset:0 sc0 sc1
    s_mov_b64 exec, -1
    s_waitcnt vmcnt(0)
    v_cmp_gt_u32 vcc, 0x80, v11
    s_nop 1
    s_and_b32 s3, vcc_lo, 0x1
    s_cbranch_scc0 L_kp1_b_27
    s_sub_u32 s83, s83, 1
    s_cmp_lg_u32 s83, 0
    s_cbranch_scc1 L_kp1_s_28_l
    s_branch L_kp1_b_27
L_kp2_s_34:
    s_mov_b32 s83, 200000
L_kp2_s_34_l:
    v_mov_b32 v11, 0
    s_mov_b64 exec, 0xff
    buffer_atomic_or v11, v13, s[40:43], s72 offen offset:0 sc0 sc1
    s_mov_b64 exec, -1
    s_waitcnt vmcnt(0)
    v_cmp_gt_u32 vcc, 0x80, v11
    s_nop 1
    s_and_b32 s3, vcc_lo, 0xff
    s_cbranch_scc0 L_kp2_b_33
    s_sub_u32 s83, s83, 1
    s_cmp_lg_u32 s83, 0
    s_cbranch_scc1 L_kp2_s_34_l
    s_branch L_kp2_b_33
L_hp2_s_40:
    s_mov_b32 s83, 200000
L_hp2_s_40_l:
    v_mov_b32 v11, 0
    s_mov_b64 exec, 0x3
    buffer_atomic_or v11, v13, s[40:43], s72 offen offset:4 sc0 sc1
    s_mov_b64 exec, -1
    s_waitcnt vmcnt(0)
    v_cmp_gt_u32 vcc, 0x80, v11
    s_nop 1
    s_and_b32 s3, vcc_lo, 0x3
    s_cbranch_scc0 L_hp2_b_39
    s_sub_u32 s83, s83, 1
    s_cmp_lg_u32 s83, 0
    s_cbranch_scc1 L_hp2_s_40_l
    s_branch L_hp2_b_39
L_hp3_s_48:
    s_mov_b32 s83, 200000
L_hp3_s_48_l:
    v_mov_b32 v11, 0
    s_mov_b64 exec, 0x3
    buffer_atomic_or v11, v13, s[40:43], s72 offen offset:8 sc0 sc1
    s_mov_b64 exec, -1
    s_waitcnt vmcnt(0)
    v_cmp_gt_u32 vcc, 0x80, v11
    s_nop 1
    s_and_b32 s3, vcc_lo, 0x3
    s_cbranch_scc0 L_hp3_b_47
    s_sub_u32 s83, s83, 1
    s_cmp_lg_u32 s83, 0
    s_cbranch_scc1 L_hp3_s_48_l
    s_branch L_hp3_b_47
L_ep_s_30:
    s_mov_b32 s83, 3200000
    s_setprio 0
L_ep_s_30_l:
    ds_read_b32 v10, v9 offset:0
    s_waitcnt lgkmcnt(0)
    v_cmp_eq_u32 vcc, 0, v10
    s_nop 1
    s_cbranch_vccz L_ep_s_30_x
    s_sub_u32 s83, s83, 1
    s_cmp_lg_u32 s83, 0
    s_cbranch_scc1 L_ep_s_30_l
L_ep_s_30_x:
    s_setprio 1
    s_branch L_ep_b_29
L_ep_s_32:
    s_mov_b32 s83, 3200000
    s_setprio 0
L_ep_s_32_l:
    ds_read_b32 v10, v9 offset:32
    s_waitcnt lgkmcnt(0)
    v_cmp_eq_u32 vcc, 0, v10
    s_nop 1
    s_cbranch_vccz L_ep_s_32_x
    s_sub_u32 s83, s83, 1
    s_cmp_lg_u32 s83, 0
    s_cbranch_scc1 L_ep_s_32_l
L_ep_s_32_x:
    s_setprio 3
    s_branch L_ep_b_31
L_ep_s_36:
    s_mov_b32 s83, 3200000
    s_setprio 0
L_ep_s_36_l:
    ds_read_b32 v10, v9 offset:64
    s_waitcnt lgkmcnt(0)
    v_cmp_eq_u32 vcc, 0, v10
    s_nop 1
    s_cbranch_vccz L_ep_s_36_x
    s_sub_u32 s83, s83, 1
    s_cmp_lg_u32 s83, 0
    s_cbranch_scc1 L_ep_s_36_l
L_ep_s_36_x:
    s_setprio 2
    s_branch L_ep_b_35
L_ep_s_38:
    s_mov_b32 s83, 3200000
    s_setprio 0
L_ep_s_38_l:
    ds_read_b32 v10, v9 offset:96
    s_waitcnt lgkmcnt(0)
    v_cmp_eq_u32 vcc, 0, v10
    s_nop 1
    s_cbranch_vccz L_ep_s_38_x
    s_sub_u32 s83, s83, 1
    s_cmp_lg_u32 s83, 0
    s_cbranch_scc1 L_ep_s_38_l
L_ep_s_38_x:
    s_setprio 2
    s_branch L_ep_b_37
L_ep_s_42:
    s_mov_b32 s83, 3200000
    s_setprio 0
L_ep_s_42_l:
    ds_read_b32 v10, v9 offset:128
    s_waitcnt lgkmcnt(0)
    v_cmp_eq_u32 vcc, 0, v10
    s_nop 1
    s_cbranch_vccz L_ep_s_42_x
    s_sub_u32 s83, s83, 1
    s_cmp_lg_u32 s83, 0
    s_cbranch_scc1 L_ep_s_42_l
L_ep_s_42_x:
    s_setprio 2
    s_branch L_ep_b_41
L_ep_s_44:
    s_mov_b32 s83, 3200000
    s_setprio 0
L_ep_s_44_l:
    ds_read_b32 v10, v9 offset:160
    s_waitcnt lgkmcnt(0)
    v_cmp_eq_u32 vcc, 0, v10
    s_nop 1
    s_cbranch_vccz L_ep_s_44_x
    s_sub_u32 s83, s83, 1
    s_cmp_lg_u32 s83, 0
    s_cbranch_scc1 L_ep_s_44_l
L_ep_s_44_x:
    s_setprio 2
    s_branch L_ep_b_43
L_ep_s_46:
    s_mov_b32 s83, 3200000
    s_setprio 0
L_ep_s_46_l:
    ds_read_b32 v10, v9 offset:192
    s_waitcnt lgkmcnt(0)
    v_cmp_eq_u32 vcc, 0, v10
    s_nop 1
    s_cbranch_vccz L_ep_s_46_x
    s_sub_u32 s83, s83, 1
    s_cmp_lg_u32 s83, 0
    s_cbranch_scc1 L_ep_s_46_l
L_ep_s_46_x:
    s_setprio 2
    s_branch L_ep_b_45
L_ep_s_50:
    s_mov_b32 s83, 3200000
    s_setprio 0
L_ep_s_50_l:
    ds_read_b32 v10, v9 offset:224
    s_waitcnt lgkmcnt(0)
    v_cmp_eq_u32 vcc, 0, v10
    s_nop 1
    s_cbranch_vccz L_ep_s_50_x
    s_sub_u32 s83, s83, 1
    s_cmp_lg_u32 s83, 0
    s_cbranch_scc1 L_ep_s_50_l
L_ep_s_50_x:
    s_setprio 2
    s_branch L_ep_b_49
L_ov_s_54:
    s_mov_b32 s83, 200000
L_ov_s_54_l:
    buffer_load_dwordx4 v[32:35], v1, s[40:43], s74 offen offset:0 sc1
    buffer_load_dwordx4 v[36:39], v1, s[40:43], s74 offen offset:2048 sc1
    s_waitcnt vmcnt(0)
    v_max3_u32 v10, v32, v33, v34
    v_max3_u32 v11, v35, v36, v37
    v_max3_u32 v10, v10, v38, v39
    v_max_u32 v10, v10, v11
    v_cmp_eq_u32 vcc, -1, v10
    s_nop 1
    s_cbranch_vccz L_ov_b_53
    s_sub_u32 s83, s83, 1
    s_cmp_lg_u32 s83, 0
    s_cbranch_scc1 L_ov_s_54_l
    s_branch L_ov_b_53
L_ov_s_56:
    s_mov_b32 s83, 200000
L_ov_s_56_l:
    buffer_load_dwordx4 v[40:43], v1, s[40:43], s79 offen offset:0 sc1
    buffer_load_dwordx4 v[44:47], v1, s[40:43], s79 offen offset:2048 sc1
    s_waitcnt vmcnt(0)
    v_max3_u32 v10, v40, v41, v42
    v_max3_u32 v11, v43, v44, v45
    v_max3_u32 v10, v10, v46, v47
    v_max_u32 v10, v10, v11
    v_cmp_eq_u32 vcc, -1, v10
    s_nop 1
    s_cbranch_vccz L_ov_b_55
    s_sub_u32 s83, s83, 1
    s_cmp_lg_u32 s83, 0
    s_cbranch_scc1 L_ov_s_56_l
    s_branch L_ov_b_55
L_ov_s_58:
    s_mov_b32 s83, 200000
L_ov_s_58_l:
    buffer_load_dwordx4 v[48:51], v1, s[40:43], s74 offen offset:1024 sc1
    buffer_load_dwordx4 v[52:55], v1, s[40:43], s74 offen offset:3072 sc1
    s_waitcnt vmcnt(0)
    v_max3_u32 v10, v48, v49, v50
    v_max3_u32 v11, v51, v52, v53
    v_max3_u32 v10, v10, v54, v55
    v_max_u32 v10, v10, v11
    v_cmp_eq_u32 vcc, -1, v10
    s_nop 1
    s_cbranch_vccz L_ov_b_57
    s_sub_u32 s83, s83, 1
    s_cmp_lg_u32 s83, 0
    s_cbranch_scc1 L_ov_s_58_l
    s_branch L_ov_b_57
L_ov_s_60:
    s_mov_b32 s83, 200000
L_ov_s_60_l:
    buffer_load_dwordx4 v[56:59], v1, s[40:43], s79 offen offset:1024 sc1
    buffer_load_dwordx4 v[60:63], v1, s[40:43], s79 offen offset:3072 sc1
    s_waitcnt vmcnt(0)
    v_max3_u32 v10, v56, v57, v58
    v_max3_u32 v11, v59, v60, v61
    v_max3_u32 v10, v10, v62, v63
    v_max_u32 v10, v10, v11
    v_cmp_eq_u32 vcc, -1, v10
    s_nop 1
    s_cbranch_vccz L_ov_b_59
    s_sub_u32 s83, s83, 1
    s_cmp_lg_u32 s83, 0
    s_cbranch_scc1 L_ov_s_60_l
    s_branch L_ov_b_59
L_init_s_7:
    s_mov_b32 s83, 200000
L_init_s_7_l:
    v_lshrrev_b32 v11, 2, v1
    s_mov_b64 exec, 0xf
    buffer_load_dword v11, v11, s[36:39], 0 offen sc1
    s_mov_b64 exec, -1
    s_waitcnt vmcnt(0)
    v_cmp_gt_u32 vcc, 0x80, v11
    s_nop 1
    s_and_b32 s3, vcc_lo, 0xf
    s_cbranch_scc0 L_init_b_6
    s_sub_u32 s83, s83, 1
    s_cmp_lg_u32 s83, 0
    s_cbranch_scc1 L_init_s_7_l
    s_branch L_init_b_6
L_init_s_11:
    s_mov_b32 s83, 200000
L_init_s_11_l:
    v_lshrrev_b32 v11, 2, v1
    s_mov_b64 exec, 0xf
    buffer_load_dword v11, v11, s[36:39], 0 offen sc1
    s_mov_b64 exec, -1
    s_waitcnt vmcnt(0)
    v_cmp_gt_u32 vcc, 0x80, v11
    s_nop 1
    s_and_b32 s3, vcc_lo, 0xf
    s_cbranch_scc0 L_init_b_10
    s_sub_u32 s83, s83, 1
    s_cmp_lg_u32 s83, 0
    s_cbranch_scc1 L_init_s_11_l
    s_branch L_init_b_10
L_init_s_15:
    s_mov_b32 s83, 200000
L_init_s_15_l:
    v_lshrrev_b32 v11, 2, v1
    s_mov_b64 exec, 0xf
    buffer_load_dword v11, v11, s[36:39], 0 offen sc1
    s_mov_b64 exec, -1
    s_waitcnt vmcnt(0)
    v_cmp_gt_u32 vcc, 0x80, v11
    s_nop 1
    s_and_b32 s3, vcc_lo, 0xf
    s_cbranch_scc0 L_init_b_14
    s_sub_u32 s83, s83, 1
    s_cmp_lg_u32 s83, 0
    s_cbranch_scc1 L_init_s_15_l
    s_branch L_init_b_14
L_init_s_24:
    s_mov_b32 s83, 200000
L_init_s_24_l:
    v_lshrrev_b32 v11, 2, v1
    s_mov_b64 exec, 0xf
    buffer_load_dword v11, v11, s[36:39], 0 offen sc1
    s_mov_b64 exec, -1
    s_waitcnt vmcnt(0)
    v_cmp_gt_u32 vcc, 0x80, v11
    s_nop 1
    s_and_b32 s3, vcc_lo, 0xf
    s_cbranch_scc0 L_init_b_23
    s_sub_u32 s83, s83, 1
    s_cmp_lg_u32 s83, 0
    s_cbranch_scc1 L_init_s_24_l
    s_branch L_init_b_23
L_fallback:
    s_waitcnt vmcnt(0) lgkmcnt(0)
    v_mov_b32 v10, 0xff800000
    s_lshl_b32 s82, s53, 17
    s_add_u32 s82, s82, 1048576
    s_mov_b32 s83, 64
L_fb1:
    buffer_load_dwordx4 v[20:23], v1, s[40:43], s82 offen sc1
    s_waitcnt vmcnt(0)
    v_mfma_f32_32x32x16_bf16 v[32:47], v[20:23], v[16:19], 0
    s_nop 11
    v_max3_f32 v10, v10, v32, v33
    v_max3_f32 v10, v10, v34, v35
    v_max3_f32 v10, v10, v36, v37
    v_max3_f32 v10, v10, v38, v39
    v_max3_f32 v10, v10, v40, v41
    v_max3_f32 v10, v10, v42, v43
    v_max3_f32 v10, v10, v44, v45
    v_max3_f32 v10, v10, v46, v47
    s_add_u32 s82, s82, 2048
    s_sub_u32 s83, s83, 1
    s_cmp_lg_u32 s83, 0
    s_cbranch_scc1 L_fb1
    v_mov_b32 v11, v10
    s_nop 1
    v_permlane32_swap_b32 v10, v11
    v_max_f32 v10, v10, v11
    v_sub_f32 v48, 0, v10
    v_sub_f32 v49, 0, v10
    v_sub_f32 v50, 0, v10
    v_sub_f32 v51, 0, v10
    v_sub_f32 v52, 0, v10
    v_sub_f32 v53, 0, v10
    v_sub_f32 v54, 0, v10
    v_sub_f32 v55, 0, v10
    v_sub_f32 v56, 0, v10
    v_sub_f32 v57, 0, v10
    v_sub_f32 v58, 0, v10
    v_sub_f32 v59, 0, v10
    v_sub_f32 v60, 0, v10
    v_sub_f32 v61, 0, v10
    v_sub_f32 v62, 0, v10
    v_sub_f32 v63, 0, v10
    v_mov_b32 v64, 0
    v_mov_b32 v65, 0
    v_mov_b32 v66, 0
    v_mov_b32 v67, 0
    v_mov_b32 v68, 0
    v_mov_b32 v69, 0
    v_mov_b32 v70, 0
    v_mov_b32 v71, 0
    v_mov_b32 v72, 0
    v_mov_b32 v73, 0
    v_mov_b32 v74, 0
    v_mov_b32 v75, 0
    v_mov_b32 v76, 0
    v_mov_b32 v77, 0
    v_mov_b32 v78, 0
    v_mov_b32 v79, 0
    v_mov_b32 v24, 0x3f803f80
    v_mov_b32 v25, 0x3f803f80
    v_mov_b32 v26, 0x3f803f80
    v_mov_b32 v27, 0x3f803f80
    v_mov_b32 v28, 0x3f803f80
    v_mov_b32 v29, 0x3f803f80
    v_mov_b32 v30, 0x3f803f80
    v_mov_b32 v31, 0x3f803f80
    s_lshl_b32 s82, s53, 17
    s_add_u32 s82, s82, 1048576
    s_mov_b32 s83, 64
L_fb2:
    buffer_load_dwordx4 v[20:23], v1, s[40:43], s82 offen sc1
    s_mov_b32 exec_lo, 0xffff
    s_mov_b32 exec_hi, 0xffff
    buffer_load_dwordx4 v[24:27], v2, s[40:43], s82 offen sc1
    buffer_load_dwordx4 v[28:31], v2, s[40:43], s82 offen offset:256 sc1
    s_mov_b64 exec, -1
    s_waitcnt vmcnt(0)
    v_mfma_f32_32x32x16_bf16 v[32:47], v[20:23], v[16:19], v[48:63]
    s_nop 11
    v_exp_f32 v32, v32
    v_exp_f32 v33, v33
    v_exp_f32 v34, v34
    v_exp_f32 v35, v35
    v_exp_f32 v36, v36
    v_exp_f32 v37, v37
    v_exp_f32 v38, v38
    v_exp_f32 v39, v39
    v_exp_f32 v40, v40
    v_exp_f32 v41, v41
    v_exp_f32 v42, v42
    v_exp_f32 v43, v43
    v_exp_f32 v44, v44
    v_exp_f32 v45, v45
    v_exp_f32 v46, v46
    v_exp_f32 v47, v47
    v_smfmac_f32_32x32x32_bf16 v[64:79], v[24:27], v[32:39], v0
    s_nop 0
    v_smfmac_f32_32x32x32_bf16 v[64:79], v[28:31], v[40:47], v0
    s_add_u32 s82, s82, 2048
    s_sub_u32 s83, s83, 1
    s_cmp_lg_u32 s83, 0
    s_cbranch_scc1 L_fb2
    s_nop 15
    s_branch L_fb_back
L_code_end:
.fill (41472 - (L_code_end - gated_mix__mha_block__glu_gated_glu__prompt_kernel)) / 4, 4, 0xbf810000
.section .rodata,"a"
.p2align 6
.amdhsa_kernel gated_mix__mha_block__glu_gated_glu__prompt_kernel
  .amdhsa_next_free_vgpr 256
  .amdhsa_next_free_sgpr 102
  .amdhsa_accum_offset 256
  .amdhsa_group_segment_fixed_size 0
  .amdhsa_kernarg_size 88
  .amdhsa_user_sgpr_count 2
  .amdhsa_user_sgpr_kernarg_segment_ptr 1
  .amdhsa_system_sgpr_workgroup_id_x 1
.end_amdhsa_kernel
```
